```python
import torch

def _softmax(x, axis=-1):
    return torch.softmax(x, dim=axis)

def _gelu(x):
    return torch.nn.functional.gelu(x, approximate='tanh')

def _silu(x):
    return torch.nn.functional.silu(x)

def _sigmoid(x):
    return torch.sigmoid(x)

def _layernorm(x, axis=-1, eps=1e-05):
    m = x.mean(dim=axis, keepdim=True)
    v = x.var(dim=axis, keepdim=True, unbiased=False)
    return (x - m) / torch.sqrt(v + eps)

def _scatter_add(tgt, idx, src, axis=0):
    return tgt.clone().index_add_(axis, idx, src)

def _segment_sum(src, seg, n):
    out = torch.zeros((n,) + src.shape[1:], dtype=src.dtype)
    return out.index_add_(0, seg, src)

def _pad(x, pw):
    flat = tuple((v for pair in reversed(pw) for v in pair))
    return torch.nn.functional.pad(x, flat)
kernel_name = 'standalone__ragged_sequences_varlen_flash_attn__ragged'

def setup_inputs():

    _w = lambda a: (lambda t: t.to(torch.bfloat16) if t.is_floating_point() else t)(torch.as_tensor(a))
    cu = torch.tensor([0, 267, 391, 734, 1145, 1486, 1586, 1793, 1920, 2261, 2733, 2860, 2978, 3276, 3550, 4058, 4249], dtype=torch.int64)
    T = int(cu[-1])
    Hq, Hkv, D = (16, 4, 128)
    assert Hq % Hkv == 0
    return {'q': _w((lambda *s: torch.randn(*s, dtype=torch.bfloat16) * 0.8)(T, Hq, D)), 'k': _w((lambda *s: torch.randn(*s, dtype=torch.bfloat16) * 0.8)(T, Hkv, D)), 'v': _w((lambda *s: torch.randn(*s, dtype=torch.bfloat16) * 0.05)(T, Hkv, D)), 'cu': _w(cu)}

def reference(q, k, v, cu):
    T, Hq, D = q.shape
    Hkv = k.shape[1]
    rep = Hq // Hkv
    scale = D ** (-0.5)
    outs = []
    for i in range(len(cu) - 1):
        s, e = (int(cu[i]), int(cu[i + 1]))
        L = e - s
        qi = q[s:e].clone()
        ki = (lambda x, n, axis: torch.repeat_interleave(x, n, dim=axis))(k[s:e], rep, axis=1)
        vi = (lambda x, n, axis: torch.repeat_interleave(x, n, dim=axis))(v[s:e], rep, axis=1)
        logits = torch.einsum('qhd,khd->hqk', qi, ki) * scale
        ar = torch.arange(L)
        neg = (lambda x, dt: x.to(dt))(ar[None, :] > ar[:, None], logits.dtype) * -1000000000.0
        p = _softmax(logits + neg[None, :, :], axis=-1)
        outs.append(torch.einsum('hqk,khd->qhd', p, vi))
    return torch.concatenate(outs, axis=0)
```

```asm
; @launch grid=(512,1,1) block=(256,1,1) lds=76032
.amdgcn_target "amdgcn-amd-amdhsa--gfx950"
.text
.globl standalone__ragged_sequences_varlen_flash_attn__ragged_kernel
.p2align 8
.type standalone__ragged_sequences_varlen_flash_attn__ragged_kernel,@function
standalone__ragged_sequences_varlen_flash_attn__ragged_kernel:
    s_load_dwordx8 s[4:11], s[0:1], 0
    s_getpc_b64 s[28:29]
L_pc:
    s_lshl_b32 s3, s2, 5
    s_add_u32 s28, s28, L_table-L_pc
    s_addc_u32 s29, s29, 0
    s_cmp_ge_u32 s2, 512
    s_cbranch_scc1 L_end
    s_load_dwordx8 s[32:39], s[28:29], s3
    s_load_dwordx2 s[56:57], s[0:1], 32
    v_lshrrev_b32 v216, 6, v0
    v_and_b32 v231, 63, v0
    v_readfirstlane_b32 s30, v216
    v_lshrrev_b32 v217, 4, v231
    v_and_b32 v218, 15, v231
    v_and_b32 v219, 1, v217
    v_xor_b32 v219, v219, v218
    v_lshlrev_b32 v204, 12, v217
    v_lshlrev_b32 v233, 14, v217
    s_lshl_b32 s43, s30, 10
    s_lshl_b32 s44, s30, 8
    s_mul_i32 s45, s30, 2112
    v_add_u32 v204, s43, v204
    v_add_u32 v233, s44, v233
    v_lshl_add_u32 v202, v219, 4, v204
    v_lshl_add_u32 v233, v219, 4, v233
    v_add_u32 v203, 15328, v202
    v_add_u32 v235, 64480, v233
    s_mov_b32 s19, 0x20000
    s_mov_b32 s15, s19
    s_movk_i32 s49, 1984
    s_movk_i32 s50, 8192
    s_movk_i32 s51, 10176
    s_mul_i32 s59, s30, 8448
    s_add_u32 s59, s59, 42240
    s_cmp_eq_u32 s30, 0
    s_cselect_b32 s59, 25344, s59
    s_mov_b32 m0, s45
    s_waitcnt lgkmcnt(0)
    s_add_u32 s16, s6, s34
    s_addc_u32 s17, s7, 0
    s_mov_b32 s18, s35
    s_add_u32 s12, s4, s32
    s_addc_u32 s13, s5, 0
    s_mov_b32 s14, s33
    s_mov_b32 s40, s36
    s_bitcmp1_b32 s39, 1
    s_cbranch_scc1 L_thr_setup
    buffer_load_dwordx4 v202, s[16:19], s40 offen lds
    buffer_load_dwordx4 v203, s[16:19], s40 offen offset:1056 lds
    s_mov_b32 m0, s59
    s_nop 0
    buffer_load_dwordx4 v233, s[12:15], 0 offen lds
    buffer_load_dwordx4 v235, s[12:15], 0 offen offset:1056 lds
    buffer_load_dwordx4 v233, s[12:15], s49 offen offset:2112 lds
    buffer_load_dwordx4 v235, s[12:15], s49 offen offset:3168 lds
    s_add_u32 m0, s59, 4224
    s_nop 0
    buffer_load_dwordx4 v233, s[12:15], s50 offen lds
    buffer_load_dwordx4 v235, s[12:15], s50 offen offset:1056 lds
    buffer_load_dwordx4 v233, s[12:15], s51 offen offset:2112 lds
    buffer_load_dwordx4 v235, s[12:15], s51 offen offset:3168 lds
    v_lshl_add_u32 v204, v218, 4, v204
    v_add_u32 v205, 15360, v204
    s_add_u32 s20, s8, s34
    s_addc_u32 s21, s9, 0
    s_mov_b32 s22, s35
    s_mov_b32 s23, s19
    s_add_u32 m0, s45, 33792
    s_nop 0
    buffer_load_dwordx4 v204, s[20:23], s40 offen lds
    buffer_load_dwordx4 v205, s[20:23], s40 offen offset:1024 lds
    s_cmp_lt_u32 s37, 2
    s_cbranch_scc1 L_no_t1
    s_add_u32 m0, s45, 8448
    s_sub_u32 s40, s40, 0x8000
    buffer_load_dwordx4 v202, s[16:19], s40 offen lds
    buffer_load_dwordx4 v203, s[16:19], s40 offen offset:1056 lds
    s_add_u32 m0, s45, 42240
    s_nop 0
    buffer_load_dwordx4 v204, s[20:23], s40 offen lds
    buffer_load_dwordx4 v205, s[20:23], s40 offen offset:1024 lds
    s_cmp_lt_u32 s37, 3
    s_cbranch_scc1 L_no_t1
    s_add_u32 m0, s45, 16896
    s_sub_u32 s40, s40, 0x8000
    buffer_load_dwordx4 v202, s[16:19], s40 offen lds
    buffer_load_dwordx4 v203, s[16:19], s40 offen offset:1056 lds
L_no_t1:
    s_branch L_setup
L_thr_setup:
    v_lshl_add_u32 v204, v218, 4, v204
    v_add_u32 v205, 15360, v204
L_setup:
    s_add_u32 s20, s8, s34
    s_addc_u32 s21, s9, 0
    s_mov_b32 s22, s35
    s_mov_b32 s23, s19
    s_mov_b32 s27, s19
    s_mov_b32 s31, s37
    s_bitcmp1_b32 s39, 0
    s_cbranch_scc0 L_noprio
    s_setprio 2
L_noprio:
    s_add_u32 s24, s56, s32
    s_addc_u32 s25, s57, 0
    s_mov_b32 s26, s33
    s_mov_b32 s47, 0x427af233
    v_mov_b32 v229, 0x3e0293ee
    v_and_b32 v216, 3, v231
    v_bfe_u32 v217, v231, 2, 2
    v_bfe_u32 v218, v231, 4, 1
    v_lshrrev_b32 v219, 5, v231
    v_mul_u32_u24 v206, 1056, v218
    v_lshl_add_u32 v206, v217, 8, v206
    v_and_b32 v214, 1, v217
    v_xor_b32 v214, v214, v219
    v_lshl_add_u32 v206, v214, 4, v206
    v_mul_u32_u24 v214, 2112, v216
    v_add_u32 v206, v206, v214
    v_add_u32 v234, s59, v206
    v_mul_u32_u24 v207, 2112, v217
    v_lshl_add_u32 v207, v219, 8, v207
    v_lshl_add_u32 v207, v218, 5, v207
    v_and_b32 v214, 1, v216
    v_lshrrev_b32 v215, 1, v216
    v_lshl_add_u32 v207, v214, 4, v207
    v_lshl_add_u32 v207, v215, 3, v207
    v_add_u32 v207, 33792, v207
    v_add_u32 v208, s38, v207
    v_and_b32 v232, 31, v231
    v_lshrrev_b32 v214, 4, v231
    v_and_b32 v215, 15, v231
    s_and_b32 s43, s30, 1
    s_mul_i32 s43, s43, 8704
    s_mov_b32 s44, 50688
    s_cmp_lt_u32 s30, 2
    s_cselect_b32 s44, 16896, s44
    s_add_u32 s43, s43, s44
    v_mul_u32_u24 v236, 272, v232
    v_lshl_add_u32 v236, v219, 4, v236
    v_add_u32 v236, s43, v236
    v_lshrrev_b32 v251, 3, v231
    v_and_b32 v252, 7, v231
    v_mul_u32_u24 v237, 272, v251
    v_lshl_add_u32 v237, v252, 4, v237
    v_add_u32 v237, s43, v237
    s_lshl_b32 s43, s30, 8
    v_lshlrev_b32 v250, 12, v251
    v_lshl_add_u32 v250, v252, 4, v250
    v_add_u32 v250, s43, v250
    v_add_u32 v251, 32768, v250
    v_add_u32 v252, 65536, v250
    v_add_u32 v253, 98304, v250
    v_and_b32 v214, 1, v214
    v_cmp_eq_u32 vcc, v214, v215
    v_mov_b32 v230, 0x3f803f80
    s_nop 0
    v_cndmask_b32 v240, 0, v230, vcc
    v_cndmask_b32 v241, 0, v230, vcc
    v_cndmask_b32 v242, 0, v230, vcc
    v_cndmask_b32 v243, 0, v230, vcc
    v_mov_b32 v244, 0
    v_mov_b32 v245, 0
    v_mov_b32 v246, 0
    v_mov_b32 v247, 0
    v_lshlrev_b32 v214, 2, v219
    v_sub_u32 v232, v232, v214
    v_mov_b32 v230, 0xf149f2ca
    v_cmp_gt_i32 s[64:65], 0, v232
    v_cmp_gt_i32 s[66:67], 1, v232
    v_cmp_gt_i32 s[68:69], 2, v232
    v_cmp_gt_i32 s[70:71], 3, v232
    v_cndmask_b32 v98, 0, v230, s[64:65]
    v_cndmask_b32 v99, 0, v230, s[66:67]
    v_cndmask_b32 v100, 0, v230, s[68:69]
    v_cndmask_b32 v101, 0, v230, s[70:71]
    v_cmp_gt_i32 s[64:65], 8, v232
    v_cmp_gt_i32 s[66:67], 9, v232
    v_cmp_gt_i32 s[68:69], 10, v232
    v_cmp_gt_i32 s[70:71], 11, v232
    v_cndmask_b32 v102, 0, v230, s[64:65]
    v_cndmask_b32 v103, 0, v230, s[66:67]
    v_cndmask_b32 v104, 0, v230, s[68:69]
    v_cndmask_b32 v105, 0, v230, s[70:71]
    v_cmp_gt_i32 s[64:65], 16, v232
    v_cmp_gt_i32 s[66:67], 17, v232
    v_cmp_gt_i32 s[68:69], 18, v232
    v_cmp_gt_i32 s[70:71], 19, v232
    v_cndmask_b32 v106, 0, v230, s[64:65]
    v_cndmask_b32 v107, 0, v230, s[66:67]
    v_cndmask_b32 v108, 0, v230, s[68:69]
    v_cndmask_b32 v109, 0, v230, s[70:71]
    v_cmp_gt_i32 s[64:65], 24, v232
    v_cmp_gt_i32 s[66:67], 25, v232
    v_cmp_gt_i32 s[68:69], 26, v232
    v_cmp_gt_i32 s[70:71], 27, v232
    v_cndmask_b32 v110, 0, v230, s[64:65]
    v_cndmask_b32 v111, 0, v230, s[66:67]
    v_cndmask_b32 v112, 0, v230, s[68:69]
    v_cndmask_b32 v113, 0, v230, s[70:71]
    v_mov_b32 v130, 0
    v_mov_b32 v131, 0
    v_mov_b32 v132, 0
    v_mov_b32 v133, 0
    s_nop 1
    v_mfma_f32_32x32x16_bf16 v[34:49], v[130:133], v[130:133], 0
    v_mfma_f32_32x32x16_bf16 v[50:65], v[130:133], v[130:133], 0
    v_mfma_f32_32x32x16_bf16 v[66:81], v[130:133], v[130:133], 0
    v_mfma_f32_32x32x16_bf16 v[82:97], v[130:133], v[130:133], 0
    s_sub_u32 s46, s31, 6
    s_add_u32 s43, s31, 0
    s_and_b32 s43, s43, 3
    s_mul_i32 s60, s43, 8448
    s_add_u32 s43, s31, 1
    s_and_b32 s43, s43, 3
    s_mul_i32 s61, s43, 8448
    s_add_u32 s43, s31, 2
    s_and_b32 s43, s43, 3
    s_mul_i32 s62, s43, 8448
    s_add_u32 s43, s31, 3
    s_and_b32 s43, s43, 3
    s_mul_i32 s63, s43, 8448
    s_add_u32 s42, s45, 33792
    s_sub_u32 s41, s36, 0x18000
    s_bitcmp1_b32 s39, 1
    s_cbranch_scc0 L_loaded
    s_mov_b32 m0, s45
    s_nop 0
    buffer_load_dwordx4 v202, s[16:19], s40 offen lds
    s_waitcnt vmcnt(1)
    buffer_load_dwordx4 v203, s[16:19], s40 offen offset:1056 lds
    s_waitcnt vmcnt(1)
    s_mov_b32 m0, s59
    s_nop 0
    buffer_load_dwordx4 v233, s[12:15], 0 offen lds
    s_waitcnt vmcnt(1)
    buffer_load_dwordx4 v235, s[12:15], 0 offen offset:1056 lds
    s_waitcnt vmcnt(2)
    buffer_load_dwordx4 v233, s[12:15], s49 offen offset:2112 lds
    s_waitcnt vmcnt(2)
    buffer_load_dwordx4 v235, s[12:15], s49 offen offset:3168 lds
    s_waitcnt vmcnt(3)
    s_add_u32 m0, s59, 4224
    s_nop 0
    buffer_load_dwordx4 v233, s[12:15], s50 offen lds
    s_waitcnt vmcnt(4)
    buffer_load_dwordx4 v235, s[12:15], s50 offen offset:1056 lds
    s_waitcnt vmcnt(5)
    buffer_load_dwordx4 v233, s[12:15], s51 offen offset:2112 lds
    s_waitcnt vmcnt(6)
    buffer_load_dwordx4 v235, s[12:15], s51 offen offset:3168 lds
    s_waitcnt vmcnt(7)
    s_add_u32 m0, s45, 33792
    s_nop 0
    buffer_load_dwordx4 v204, s[20:23], s40 offen lds
    s_waitcnt vmcnt(7)
    buffer_load_dwordx4 v205, s[20:23], s40 offen offset:1024 lds
    s_waitcnt vmcnt(7)
    s_cmp_lt_u32 s37, 2
    s_cbranch_scc1 L_no_t1b
    s_add_u32 m0, s45, 8448
    s_sub_u32 s40, s40, 0x8000
    buffer_load_dwordx4 v202, s[16:19], s40 offen lds
    buffer_load_dwordx4 v203, s[16:19], s40 offen offset:1056 lds
    s_add_u32 m0, s45, 42240
    s_nop 0
    buffer_load_dwordx4 v204, s[20:23], s40 offen lds
    buffer_load_dwordx4 v205, s[20:23], s40 offen offset:1024 lds
    s_cmp_lt_u32 s37, 3
    s_cbranch_scc1 L_no_t1b
    s_add_u32 m0, s45, 16896
    s_sub_u32 s40, s40, 0x8000
    buffer_load_dwordx4 v202, s[16:19], s40 offen lds
    buffer_load_dwordx4 v203, s[16:19], s40 offen offset:1056 lds
L_no_t1b:
L_loaded:
    s_cmp_lt_u32 s31, 3
    s_cbranch_scc1 L_w12
    s_waitcnt vmcnt(8)
    s_branch L_w2d
L_w12:
    s_cmp_lt_u32 s31, 2
    s_cbranch_scc1 L_w2
    s_waitcnt vmcnt(6)
    s_branch L_w2d
L_w2:
    s_waitcnt vmcnt(2)
L_w2d:
    ds_read_b128 v[2:5], v234 offset:0
    ds_read_b128 v[6:9], v234 offset:32
    ds_read_b128 v[10:13], v234 offset:64
    ds_read_b128 v[14:17], v234 offset:96
    ds_read_b128 v[18:21], v234 offset:128
    ds_read_b128 v[22:25], v234 offset:160
    ds_read_b128 v[26:29], v234 offset:192
    ds_read_b128 v[30:33], v234 offset:224
    s_waitcnt lgkmcnt(0)
    s_barrier
    ds_read_b128 v[138:141], v206 offset:0
    ds_read_b128 v[142:145], v206 offset:32
    ds_read_b128 v[146:149], v206 offset:64
    ds_read_b128 v[150:153], v206 offset:96
    ds_read_b128 v[154:157], v206 offset:128
    ds_read_b128 v[158:161], v206 offset:160
    ds_read_b128 v[162:165], v206 offset:192
    ds_read_b128 v[166:169], v206 offset:224
    s_cmp_lt_u32 s31, 4
    s_cbranch_scc1 L_short
    s_waitcnt lgkmcnt(7)
    v_mfma_f32_32x32x16_bf16 v[98:113], v[138:141], v[2:5], v[98:113]
    s_add_u32 m0, s45, 50688
    s_waitcnt lgkmcnt(6)
    v_mfma_f32_32x32x16_bf16 v[98:113], v[142:145], v[6:9], v[98:113]
    buffer_load_dwordx4 v204, s[20:23], s40 offen lds
    s_waitcnt lgkmcnt(5)
    v_mfma_f32_32x32x16_bf16 v[98:113], v[146:149], v[10:13], v[98:113]
    s_waitcnt lgkmcnt(4)
    v_mfma_f32_32x32x16_bf16 v[98:113], v[150:153], v[14:17], v[98:113]
    buffer_load_dwordx4 v205, s[20:23], s40 offen offset:1024 lds
    s_add_u32 m0, s45, 25344
    s_sub_u32 s40, s40, 0x8000
    s_waitcnt lgkmcnt(3)
    v_mfma_f32_32x32x16_bf16 v[98:113], v[154:157], v[18:21], v[98:113]
    s_waitcnt lgkmcnt(2)
    v_mfma_f32_32x32x16_bf16 v[98:113], v[158:161], v[22:25], v[98:113]
    buffer_load_dwordx4 v202, s[16:19], s40 offen lds
    s_waitcnt lgkmcnt(1)
    v_mfma_f32_32x32x16_bf16 v[98:113], v[162:165], v[26:29], v[98:113]
    s_waitcnt lgkmcnt(0)
    v_mfma_f32_32x32x16_bf16 v[98:113], v[166:169], v[30:33], v[98:113]
    buffer_load_dwordx4 v203, s[16:19], s40 offen offset:1056 lds
    s_waitcnt vmcnt(8)
    s_barrier
    s_cmp_lt_u32 s31, 5
    s_cbranch_scc1 L_no_k4
    s_add_u32 m0, s45, 0
    s_nop 0
    s_sub_u32 s40, s40, 0x8000
    buffer_load_dwordx4 v202, s[16:19], s40 offen lds
    buffer_load_dwordx4 v203, s[16:19], s40 offen offset:1056 lds
L_no_k4:
    ds_read_b128 v[138:141], v206 offset:8448
    ds_read_b128 v[142:145], v206 offset:8480
    ds_read_b128 v[146:149], v206 offset:8512
    ds_read_b128 v[150:153], v206 offset:8544
    ds_read_b128 v[154:157], v206 offset:8576
    ds_read_b128 v[158:161], v206 offset:8608
    ds_read_b128 v[162:165], v206 offset:8640
    ds_read_b128 v[166:169], v206 offset:8672
    s_branch L_max0
L_short:
    s_waitcnt lgkmcnt(0)
    v_mfma_f32_32x32x16_bf16 v[98:113], v[138:141], v[2:5], v[98:113]
    v_mfma_f32_32x32x16_bf16 v[98:113], v[142:145], v[6:9], v[98:113]
    v_mfma_f32_32x32x16_bf16 v[98:113], v[146:149], v[10:13], v[98:113]
    v_mfma_f32_32x32x16_bf16 v[98:113], v[150:153], v[14:17], v[98:113]
    v_mfma_f32_32x32x16_bf16 v[98:113], v[154:157], v[18:21], v[98:113]
    v_mfma_f32_32x32x16_bf16 v[98:113], v[158:161], v[22:25], v[98:113]
    v_mfma_f32_32x32x16_bf16 v[98:113], v[162:165], v[26:29], v[98:113]
    v_mfma_f32_32x32x16_bf16 v[98:113], v[166:169], v[30:33], v[98:113]
    s_cmp_lt_u32 s31, 3
    s_cbranch_scc1 L_n12
    s_add_u32 m0, s45, 50688
    s_nop 0
    buffer_load_dwordx4 v204, s[20:23], s40 offen lds
    buffer_load_dwordx4 v205, s[20:23], s40 offen offset:1024 lds
    s_waitcnt vmcnt(6)
    s_branch L_nd
L_n12:
    s_bitcmp1_b32 s39, 2
    s_cbranch_scc1 L_n2f
    s_waitcnt vmcnt(0)
    s_branch L_nd
L_n2f:
    s_sub_u32 s12, s12, 0x20000
    s_subb_u32 s13, s13, 0
    s_mov_b32 m0, s59
    s_nop 0
    buffer_load_dwordx4 v233, s[12:15], 0 offen lds
    buffer_load_dwordx4 v235, s[12:15], 0 offen offset:1056 lds
    buffer_load_dwordx4 v233, s[12:15], s49 offen offset:2112 lds
    buffer_load_dwordx4 v235, s[12:15], s49 offen offset:3168 lds
    s_add_u32 m0, s59, 4224
    s_nop 0
    buffer_load_dwordx4 v233, s[12:15], s50 offen lds
    buffer_load_dwordx4 v235, s[12:15], s50 offen offset:1056 lds
    buffer_load_dwordx4 v233, s[12:15], s51 offen offset:2112 lds
    buffer_load_dwordx4 v235, s[12:15], s51 offen offset:3168 lds
    s_waitcnt vmcnt(10)
L_nd:
    s_barrier
    s_nop 0
    ds_read_b128 v[138:141], v206 offset:8448
    ds_read_b128 v[142:145], v206 offset:8480
    ds_read_b128 v[146:149], v206 offset:8512
    ds_read_b128 v[150:153], v206 offset:8544
    ds_read_b128 v[154:157], v206 offset:8576
    ds_read_b128 v[158:161], v206 offset:8608
    ds_read_b128 v[162:165], v206 offset:8640
    ds_read_b128 v[166:169], v206 offset:8672
L_max0:
    v_max3_f32 v214, v98, v99, v100
    v_max3_f32 v215, v101, v102, v103
    v_max3_f32 v214, v214, v104, v105
    v_max3_f32 v215, v215, v106, v107
    v_max3_f32 v214, v214, v108, v109
    v_max3_f32 v215, v215, v110, v111
    v_max3_f32 v214, v214, v112, v113
    v_max_f32 v214, v214, v215
    v_mov_b32 v216, v214
    s_nop 1
    v_permlane32_swap_b32 v214, v216
    v_max_f32 v214, v214, v216
    v_mov_b32 v228, v214
    v_mul_f32 v210, v229, v214
    v_add_f32 v211, s47, v214
    v_fma_f32 v114, v98, v229, -v210
    v_fma_f32 v115, v99, v229, -v210
    v_fma_f32 v116, v100, v229, -v210
    v_fma_f32 v117, v101, v229, -v210
    v_fma_f32 v118, v102, v229, -v210
    v_fma_f32 v119, v103, v229, -v210
    v_fma_f32 v120, v104, v229, -v210
    v_fma_f32 v121, v105, v229, -v210
    v_fma_f32 v122, v106, v229, -v210
    v_fma_f32 v123, v107, v229, -v210
    v_fma_f32 v124, v108, v229, -v210
    v_fma_f32 v125, v109, v229, -v210
    v_fma_f32 v126, v110, v229, -v210
    v_fma_f32 v127, v111, v229, -v210
    v_fma_f32 v128, v112, v229, -v210
    v_fma_f32 v129, v113, v229, -v210
    s_cmp_lt_u32 s31, 4
    s_cbranch_scc1 L_d123
    s_cmp_lt_u32 s31, 6
    s_cbranch_scc0 L_steady0
    s_cmp_eq_u32 s31, 5
    s_cbranch_scc1 L_e4
    s_branch L_e3
L_d123:
    s_cmp_eq_u32 s31, 3
    s_cbranch_scc1 L_e2
    s_cmp_eq_u32 s31, 2
    s_cbranch_scc1 L_e1
    s_branch L_tail
L_steady0:
    s_waitcnt lgkmcnt(0)
    s_nop 0
    v_mfma_f32_32x32x16_bf16 v[98:113], v[138:141], v[2:5], 0
    s_add_u32 m0, s45, 59136
    ds_read_b64_tr_b16 v[170:171], v207 offset:0
    ds_read_b64_tr_b16 v[172:173], v207 offset:512
    ds_read_b64_tr_b16 v[174:175], v207 offset:64
    v_exp_f32_e64 v220, v114
    v_mfma_f32_32x32x16_bf16 v[98:113], v[142:145], v[6:9], v[98:113]
    buffer_load_dwordx4 v204, s[20:23], s41 offen lds
    ds_read_b64_tr_b16 v[176:177], v207 offset:576
    ds_read_b64_tr_b16 v[178:179], v207 offset:128
    ds_read_b64_tr_b16 v[180:181], v207 offset:640
    v_exp_f32_e64 v221, v115
    v_mfma_f32_32x32x16_bf16 v[98:113], v[146:149], v[10:13], v[98:113]
    ds_read_b64_tr_b16 v[182:183], v207 offset:192
    ds_read_b64_tr_b16 v[184:185], v207 offset:704
    ds_read_b64_tr_b16 v[186:187], v207 offset:1024
    v_exp_f32_e64 v222, v116
    v_cvt_pk_bf16_f32 v130, v220, v221
    v_mfma_f32_32x32x16_bf16 v[98:113], v[150:153], v[14:17], v[98:113]
    ds_read_b64_tr_b16 v[188:189], v207 offset:1536
    ds_read_b64_tr_b16 v[190:191], v207 offset:1088
    v_exp_f32 v223, v117
    v_exp_f32 v224, v118
    v_mfma_f32_32x32x16_bf16 v[98:113], v[154:157], v[18:21], v[98:113]
    ds_read_b64_tr_b16 v[192:193], v207 offset:1600
    ds_read_b64_tr_b16 v[194:195], v207 offset:1152
    ds_read_b64_tr_b16 v[196:197], v207 offset:1664
    v_exp_f32_e64 v225, v119
    v_cvt_pk_bf16_f32 v131, v222, v223
    v_mfma_f32_32x32x16_bf16 v[98:113], v[158:161], v[22:25], v[98:113]
    buffer_load_dwordx4 v205, s[20:23], s41 offen offset:1024 lds
    ds_read_b64_tr_b16 v[198:199], v207 offset:1216
    ds_read_b64_tr_b16 v[200:201], v207 offset:1728
    v_exp_f32_e64 v226, v120
    v_cvt_pk_bf16_f32 v132, v224, v225
    v_mfma_f32_32x32x16_bf16 v[98:113], v[162:165], v[26:29], v[98:113]
    s_sub_u32 s41, s41, 0x8000
    v_exp_f32 v227, v121
    v_exp_f32 v220, v122
    v_cvt_pk_bf16_f32 v133, v226, v227
    v_mfma_f32_32x32x16_bf16 v[98:113], v[166:169], v[30:33], v[98:113]
    v_exp_f32 v221, v123
    v_exp_f32 v222, v124
    v_cvt_pk_bf16_f32 v134, v220, v221
    s_waitcnt vmcnt(8) lgkmcnt(0)
    v_mfma_f32_32x32x16_bf16 v[34:49], v[170:173], v[130:133], v[34:49]
    s_barrier
    s_add_u32 m0, s45, 8448
    s_sub_u32 s40, s40, 0x8000
    v_exp_f32_e64 v223, v125
    v_mfma_f32_32x32x16_bf16 v[50:65], v[174:177], v[130:133], v[50:65]
    buffer_load_dwordx4 v202, s[16:19], s40 offen lds
    ds_read_b128 v[138:141], v206 offset:16896
    ds_read_b128 v[142:145], v206 offset:16928
    v_exp_f32_e64 v224, v126
    v_cvt_pk_bf16_f32 v135, v222, v223
    v_mfma_f32_32x32x16_bf16 v[66:81], v[178:181], v[130:133], v[66:81]
    ds_read_b128 v[146:149], v206 offset:16960
    ds_read_b128 v[150:153], v206 offset:16992
    v_exp_f32 v225, v127
    v_exp_f32 v226, v128
    v_mfma_f32_32x32x16_bf16 v[82:97], v[182:185], v[130:133], v[82:97]
    ds_read_b128 v[154:157], v206 offset:17024
    ds_read_b128 v[158:161], v206 offset:17056
    v_exp_f32_e64 v227, v129
    v_cvt_pk_bf16_f32 v136, v224, v225
    v_cvt_pk_bf16_f32 v137, v226, v227
    v_mfma_f32_16x16x32_bf16 v[244:247], v[240:243], v[130:133], v[244:247]
    ds_read_b128 v[162:165], v206 offset:17088
    ds_read_b128 v[166:169], v206 offset:17120
    v_mfma_f32_32x32x16_bf16 v[34:49], v[186:189], v[134:137], v[34:49]
    buffer_load_dwordx4 v203, s[16:19], s40 offen offset:1056 lds
    v_max3_f32 v214, v98, v99, v100
    v_max3_f32 v215, v101, v102, v103
    v_max3_f32 v214, v214, v104, v105
    v_max3_f32 v215, v215, v106, v107
    v_max3_f32 v214, v214, v108, v109
    v_mfma_f32_32x32x16_bf16 v[50:65], v[190:193], v[134:137], v[50:65]
    v_max3_f32 v215, v215, v110, v111
    v_max3_f32 v214, v214, v112, v113
    v_max_f32 v214, v214, v215
    v_cmp_gt_f32 vcc, v214, v211
    v_fma_f32 v114, v98, v229, -v210
    v_fma_f32 v115, v99, v229, -v210
    v_mfma_f32_32x32x16_bf16 v[66:81], v[194:197], v[134:137], v[66:81]
    v_fma_f32 v116, v100, v229, -v210
    v_fma_f32 v117, v101, v229, -v210
    v_fma_f32 v118, v102, v229, -v210
    v_fma_f32 v119, v103, v229, -v210
    v_fma_f32 v120, v104, v229, -v210
    v_fma_f32 v121, v105, v229, -v210
    v_mfma_f32_32x32x16_bf16 v[82:97], v[198:201], v[134:137], v[82:97]
    v_fma_f32 v122, v106, v229, -v210
    v_fma_f32 v123, v107, v229, -v210
    v_fma_f32 v124, v108, v229, -v210
    v_fma_f32 v125, v109, v229, -v210
    v_fma_f32 v126, v110, v229, -v210
    v_fma_f32 v127, v111, v229, -v210
    v_mfma_f32_16x16x32_bf16 v[244:247], v[240:243], v[134:137], v[244:247]
    v_fma_f32 v128, v112, v229, -v210
    v_fma_f32 v129, v113, v229, -v210
    s_sub_u32 s46, s46, 1
    s_cbranch_vccnz L_rare_s0
L_cont_s0:
    s_cbranch_scc1 L_e4
L_steady1:
    s_waitcnt lgkmcnt(0)
    v_mfma_f32_32x32x16_bf16 v[98:113], v[138:141], v[2:5], 0
    s_add_u32 m0, s45, 33792
    ds_read_b64_tr_b16 v[170:171], v207 offset:8448
    ds_read_b64_tr_b16 v[172:173], v207 offset:8960
    ds_read_b64_tr_b16 v[174:175], v207 offset:8512
    v_exp_f32_e64 v220, v114
    v_mfma_f32_32x32x16_bf16 v[98:113], v[142:145], v[6:9], v[98:113]
    buffer_load_dwordx4 v204, s[20:23], s41 offen lds
    ds_read_b64_tr_b16 v[176:177], v207 offset:9024
    ds_read_b64_tr_b16 v[178:179], v207 offset:8576
    ds_read_b64_tr_b16 v[180:181], v207 offset:9088
    v_exp_f32_e64 v221, v115
    v_mfma_f32_32x32x16_bf16 v[98:113], v[146:149], v[10:13], v[98:113]
    ds_read_b64_tr_b16 v[182:183], v207 offset:8640
    ds_read_b64_tr_b16 v[184:185], v207 offset:9152
    ds_read_b64_tr_b16 v[186:187], v207 offset:9472
    v_exp_f32_e64 v222, v116
    v_cvt_pk_bf16_f32 v130, v220, v221
    v_mfma_f32_32x32x16_bf16 v[98:113], v[150:153], v[14:17], v[98:113]
    ds_read_b64_tr_b16 v[188:189], v207 offset:9984
    ds_read_b64_tr_b16 v[190:191], v207 offset:9536
    v_exp_f32 v223, v117
    v_exp_f32 v224, v118
    v_mfma_f32_32x32x16_bf16 v[98:113], v[154:157], v[18:21], v[98:113]
    ds_read_b64_tr_b16 v[192:193], v207 offset:10048
    ds_read_b64_tr_b16 v[194:195], v207 offset:9600
    ds_read_b64_tr_b16 v[196:197], v207 offset:10112
    v_exp_f32_e64 v225, v119
    v_cvt_pk_bf16_f32 v131, v222, v223
    v_mfma_f32_32x32x16_bf16 v[98:113], v[158:161], v[22:25], v[98:113]
    buffer_load_dwordx4 v205, s[20:23], s41 offen offset:1024 lds
    ds_read_b64_tr_b16 v[198:199], v207 offset:9664
    ds_read_b64_tr_b16 v[200:201], v207 offset:10176
    v_exp_f32_e64 v226, v120
    v_cvt_pk_bf16_f32 v132, v224, v225
    v_mfma_f32_32x32x16_bf16 v[98:113], v[162:165], v[26:29], v[98:113]
    s_sub_u32 s41, s41, 0x8000
    v_exp_f32 v227, v121
    v_exp_f32 v220, v122
    v_cvt_pk_bf16_f32 v133, v226, v227
    v_mfma_f32_32x32x16_bf16 v[98:113], v[166:169], v[30:33], v[98:113]
    v_exp_f32 v221, v123
    v_exp_f32 v222, v124
    v_cvt_pk_bf16_f32 v134, v220, v221
    s_waitcnt vmcnt(8) lgkmcnt(0)
    v_mfma_f32_32x32x16_bf16 v[34:49], v[170:173], v[130:133], v[34:49]
    s_barrier
    s_add_u32 m0, s45, 16896
    s_sub_u32 s40, s40, 0x8000
    v_exp_f32_e64 v223, v125
    v_mfma_f32_32x32x16_bf16 v[50:65], v[174:177], v[130:133], v[50:65]
    buffer_load_dwordx4 v202, s[16:19], s40 offen lds
    ds_read_b128 v[138:141], v206 offset:25344
    ds_read_b128 v[142:145], v206 offset:25376
    v_exp_f32_e64 v224, v126
    v_cvt_pk_bf16_f32 v135, v222, v223
    v_mfma_f32_32x32x16_bf16 v[66:81], v[178:181], v[130:133], v[66:81]
    ds_read_b128 v[146:149], v206 offset:25408
    ds_read_b128 v[150:153], v206 offset:25440
    v_exp_f32 v225, v127
    v_exp_f32 v226, v128
    v_mfma_f32_32x32x16_bf16 v[82:97], v[182:185], v[130:133], v[82:97]
    ds_read_b128 v[154:157], v206 offset:25472
    ds_read_b128 v[158:161], v206 offset:25504
    v_exp_f32_e64 v227, v129
    v_cvt_pk_bf16_f32 v136, v224, v225
    v_cvt_pk_bf16_f32 v137, v226, v227
    v_mfma_f32_16x16x32_bf16 v[244:247], v[240:243], v[130:133], v[244:247]
    ds_read_b128 v[162:165], v206 offset:25536
    ds_read_b128 v[166:169], v206 offset:25568
    v_mfma_f32_32x32x16_bf16 v[34:49], v[186:189], v[134:137], v[34:49]
    buffer_load_dwordx4 v203, s[16:19], s40 offen offset:1056 lds
    v_max3_f32 v214, v98, v99, v100
    v_max3_f32 v215, v101, v102, v103
    v_max3_f32 v214, v214, v104, v105
    v_max3_f32 v215, v215, v106, v107
    v_max3_f32 v214, v214, v108, v109
    v_mfma_f32_32x32x16_bf16 v[50:65], v[190:193], v[134:137], v[50:65]
    v_max3_f32 v215, v215, v110, v111
    v_max3_f32 v214, v214, v112, v113
    v_max_f32 v214, v214, v215
    v_cmp_gt_f32 vcc, v214, v211
    v_fma_f32 v114, v98, v229, -v210
    v_fma_f32 v115, v99, v229, -v210
    v_mfma_f32_32x32x16_bf16 v[66:81], v[194:197], v[134:137], v[66:81]
    v_fma_f32 v116, v100, v229, -v210
    v_fma_f32 v117, v101, v229, -v210
    v_fma_f32 v118, v102, v229, -v210
    v_fma_f32 v119, v103, v229, -v210
    v_fma_f32 v120, v104, v229, -v210
    v_fma_f32 v121, v105, v229, -v210
    v_mfma_f32_32x32x16_bf16 v[82:97], v[198:201], v[134:137], v[82:97]
    v_fma_f32 v122, v106, v229, -v210
    v_fma_f32 v123, v107, v229, -v210
    v_fma_f32 v124, v108, v229, -v210
    v_fma_f32 v125, v109, v229, -v210
    v_fma_f32 v126, v110, v229, -v210
    v_fma_f32 v127, v111, v229, -v210
    v_mfma_f32_16x16x32_bf16 v[244:247], v[240:243], v[134:137], v[244:247]
    v_fma_f32 v128, v112, v229, -v210
    v_fma_f32 v129, v113, v229, -v210
    s_sub_u32 s46, s46, 1
    s_cbranch_vccnz L_rare_s1
L_cont_s1:
    s_cbranch_scc1 L_e4
L_steady2:
    s_waitcnt lgkmcnt(0)
    v_mfma_f32_32x32x16_bf16 v[98:113], v[138:141], v[2:5], 0
    s_add_u32 m0, s45, 42240
    ds_read_b64_tr_b16 v[170:171], v207 offset:16896
    ds_read_b64_tr_b16 v[172:173], v207 offset:17408
    ds_read_b64_tr_b16 v[174:175], v207 offset:16960
    v_exp_f32_e64 v220, v114
    v_mfma_f32_32x32x16_bf16 v[98:113], v[142:145], v[6:9], v[98:113]
    buffer_load_dwordx4 v204, s[20:23], s41 offen lds
    ds_read_b64_tr_b16 v[176:177], v207 offset:17472
    ds_read_b64_tr_b16 v[178:179], v207 offset:17024
    ds_read_b64_tr_b16 v[180:181], v207 offset:17536
    v_exp_f32_e64 v221, v115
    v_mfma_f32_32x32x16_bf16 v[98:113], v[146:149], v[10:13], v[98:113]
    ds_read_b64_tr_b16 v[182:183], v207 offset:17088
    ds_read_b64_tr_b16 v[184:185], v207 offset:17600
    ds_read_b64_tr_b16 v[186:187], v207 offset:17920
    v_exp_f32_e64 v222, v116
    v_cvt_pk_bf16_f32 v130, v220, v221
    v_mfma_f32_32x32x16_bf16 v[98:113], v[150:153], v[14:17], v[98:113]
    ds_read_b64_tr_b16 v[188:189], v207 offset:18432
    ds_read_b64_tr_b16 v[190:191], v207 offset:17984
    v_exp_f32 v223, v117
    v_exp_f32 v224, v118
    v_mfma_f32_32x32x16_bf16 v[98:113], v[154:157], v[18:21], v[98:113]
    ds_read_b64_tr_b16 v[192:193], v207 offset:18496
    ds_read_b64_tr_b16 v[194:195], v207 offset:18048
    ds_read_b64_tr_b16 v[196:197], v207 offset:18560
    v_exp_f32_e64 v225, v119
    v_cvt_pk_bf16_f32 v131, v222, v223
    v_mfma_f32_32x32x16_bf16 v[98:113], v[158:161], v[22:25], v[98:113]
    buffer_load_dwordx4 v205, s[20:23], s41 offen offset:1024 lds
    ds_read_b64_tr_b16 v[198:199], v207 offset:18112
    ds_read_b64_tr_b16 v[200:201], v207 offset:18624
    v_exp_f32_e64 v226, v120
    v_cvt_pk_bf16_f32 v132, v224, v225
    v_mfma_f32_32x32x16_bf16 v[98:113], v[162:165], v[26:29], v[98:113]
    s_sub_u32 s41, s41, 0x8000
    v_exp_f32 v227, v121
    v_exp_f32 v220, v122
    v_cvt_pk_bf16_f32 v133, v226, v227
    v_mfma_f32_32x32x16_bf16 v[98:113], v[166:169], v[30:33], v[98:113]
    v_exp_f32 v221, v123
    v_exp_f32 v222, v124
    v_cvt_pk_bf16_f32 v134, v220, v221
    s_waitcnt vmcnt(8) lgkmcnt(0)
    v_mfma_f32_32x32x16_bf16 v[34:49], v[170:173], v[130:133], v[34:49]
    s_barrier
    s_add_u32 m0, s45, 25344
    s_sub_u32 s40, s40, 0x8000
    v_exp_f32_e64 v223, v125
    v_mfma_f32_32x32x16_bf16 v[50:65], v[174:177], v[130:133], v[50:65]
    buffer_load_dwordx4 v202, s[16:19], s40 offen lds
    ds_read_b128 v[138:141], v206 offset:0
    ds_read_b128 v[142:145], v206 offset:32
    v_exp_f32_e64 v224, v126
    v_cvt_pk_bf16_f32 v135, v222, v223
    v_mfma_f32_32x32x16_bf16 v[66:81], v[178:181], v[130:133], v[66:81]
    ds_read_b128 v[146:149], v206 offset:64
    ds_read_b128 v[150:153], v206 offset:96
    v_exp_f32 v225, v127
    v_exp_f32 v226, v128
    v_mfma_f32_32x32x16_bf16 v[82:97], v[182:185], v[130:133], v[82:97]
    ds_read_b128 v[154:157], v206 offset:128
    ds_read_b128 v[158:161], v206 offset:160
    v_exp_f32_e64 v227, v129
    v_cvt_pk_bf16_f32 v136, v224, v225
    v_cvt_pk_bf16_f32 v137, v226, v227
    v_mfma_f32_16x16x32_bf16 v[244:247], v[240:243], v[130:133], v[244:247]
    ds_read_b128 v[162:165], v206 offset:192
    ds_read_b128 v[166:169], v206 offset:224
    v_mfma_f32_32x32x16_bf16 v[34:49], v[186:189], v[134:137], v[34:49]
    buffer_load_dwordx4 v203, s[16:19], s40 offen offset:1056 lds
    v_max3_f32 v214, v98, v99, v100
    v_max3_f32 v215, v101, v102, v103
    v_max3_f32 v214, v214, v104, v105
    v_max3_f32 v215, v215, v106, v107
    v_max3_f32 v214, v214, v108, v109
    v_mfma_f32_32x32x16_bf16 v[50:65], v[190:193], v[134:137], v[50:65]
    v_max3_f32 v215, v215, v110, v111
    v_max3_f32 v214, v214, v112, v113
    v_max_f32 v214, v214, v215
    v_cmp_gt_f32 vcc, v214, v211
    v_fma_f32 v114, v98, v229, -v210
    v_fma_f32 v115, v99, v229, -v210
    v_mfma_f32_32x32x16_bf16 v[66:81], v[194:197], v[134:137], v[66:81]
    v_fma_f32 v116, v100, v229, -v210
    v_fma_f32 v117, v101, v229, -v210
    v_fma_f32 v118, v102, v229, -v210
    v_fma_f32 v119, v103, v229, -v210
    v_fma_f32 v120, v104, v229, -v210
    v_fma_f32 v121, v105, v229, -v210
    v_mfma_f32_32x32x16_bf16 v[82:97], v[198:201], v[134:137], v[82:97]
    v_fma_f32 v122, v106, v229, -v210
    v_fma_f32 v123, v107, v229, -v210
    v_fma_f32 v124, v108, v229, -v210
    v_fma_f32 v125, v109, v229, -v210
    v_fma_f32 v126, v110, v229, -v210
    v_fma_f32 v127, v111, v229, -v210
    v_mfma_f32_16x16x32_bf16 v[244:247], v[240:243], v[134:137], v[244:247]
    v_fma_f32 v128, v112, v229, -v210
    v_fma_f32 v129, v113, v229, -v210
    s_sub_u32 s46, s46, 1
    s_cbranch_vccnz L_rare_s2
L_cont_s2:
    s_cbranch_scc1 L_e4
L_steady3:
    s_waitcnt lgkmcnt(0)
    v_mfma_f32_32x32x16_bf16 v[98:113], v[138:141], v[2:5], 0
    s_add_u32 m0, s45, 50688
    ds_read_b64_tr_b16 v[170:171], v207 offset:25344
    ds_read_b64_tr_b16 v[172:173], v207 offset:25856
    ds_read_b64_tr_b16 v[174:175], v207 offset:25408
    v_exp_f32_e64 v220, v114
    v_mfma_f32_32x32x16_bf16 v[98:113], v[142:145], v[6:9], v[98:113]
    buffer_load_dwordx4 v204, s[20:23], s41 offen lds
    ds_read_b64_tr_b16 v[176:177], v207 offset:25920
    ds_read_b64_tr_b16 v[178:179], v207 offset:25472
    ds_read_b64_tr_b16 v[180:181], v207 offset:25984
    v_exp_f32_e64 v221, v115
    v_mfma_f32_32x32x16_bf16 v[98:113], v[146:149], v[10:13], v[98:113]
    ds_read_b64_tr_b16 v[182:183], v207 offset:25536
    ds_read_b64_tr_b16 v[184:185], v207 offset:26048
    ds_read_b64_tr_b16 v[186:187], v207 offset:26368
    v_exp_f32_e64 v222, v116
    v_cvt_pk_bf16_f32 v130, v220, v221
    v_mfma_f32_32x32x16_bf16 v[98:113], v[150:153], v[14:17], v[98:113]
    ds_read_b64_tr_b16 v[188:189], v207 offset:26880
    ds_read_b64_tr_b16 v[190:191], v207 offset:26432
    v_exp_f32 v223, v117
    v_exp_f32 v224, v118
    v_mfma_f32_32x32x16_bf16 v[98:113], v[154:157], v[18:21], v[98:113]
    ds_read_b64_tr_b16 v[192:193], v207 offset:26944
    ds_read_b64_tr_b16 v[194:195], v207 offset:26496
    ds_read_b64_tr_b16 v[196:197], v207 offset:27008
    v_exp_f32_e64 v225, v119
    v_cvt_pk_bf16_f32 v131, v222, v223
    v_mfma_f32_32x32x16_bf16 v[98:113], v[158:161], v[22:25], v[98:113]
    buffer_load_dwordx4 v205, s[20:23], s41 offen offset:1024 lds
    ds_read_b64_tr_b16 v[198:199], v207 offset:26560
    ds_read_b64_tr_b16 v[200:201], v207 offset:27072
    v_exp_f32_e64 v226, v120
    v_cvt_pk_bf16_f32 v132, v224, v225
    v_mfma_f32_32x32x16_bf16 v[98:113], v[162:165], v[26:29], v[98:113]
    s_sub_u32 s41, s41, 0x8000
    v_exp_f32 v227, v121
    v_exp_f32 v220, v122
    v_cvt_pk_bf16_f32 v133, v226, v227
    v_mfma_f32_32x32x16_bf16 v[98:113], v[166:169], v[30:33], v[98:113]
    v_exp_f32 v221, v123
    v_exp_f32 v222, v124
    v_cvt_pk_bf16_f32 v134, v220, v221
    s_waitcnt vmcnt(8) lgkmcnt(0)
    v_mfma_f32_32x32x16_bf16 v[34:49], v[170:173], v[130:133], v[34:49]
    s_barrier
    s_add_u32 m0, s45, 0
    s_sub_u32 s40, s40, 0x8000
    v_exp_f32 v223, v125
    v_mfma_f32_32x32x16_bf16 v[50:65], v[174:177], v[130:133], v[50:65]
    buffer_load_dwordx4 v202, s[16:19], s40 offen lds
    ds_read_b128 v[138:141], v206 offset:8448
    ds_read_b128 v[142:145], v206 offset:8480
    v_exp_f32_e64 v224, v126
    v_cvt_pk_bf16_f32 v135, v222, v223
    v_mfma_f32_32x32x16_bf16 v[66:81], v[178:181], v[130:133], v[66:81]
    ds_read_b128 v[146:149], v206 offset:8512
    ds_read_b128 v[150:153], v206 offset:8544
    v_exp_f32 v225, v127
    v_exp_f32 v226, v128
    v_mfma_f32_32x32x16_bf16 v[82:97], v[182:185], v[130:133], v[82:97]
    ds_read_b128 v[154:157], v206 offset:8576
    ds_read_b128 v[158:161], v206 offset:8608
    v_exp_f32_e64 v227, v129
    v_cvt_pk_bf16_f32 v136, v224, v225
    v_cvt_pk_bf16_f32 v137, v226, v227
    v_mfma_f32_16x16x32_bf16 v[244:247], v[240:243], v[130:133], v[244:247]
    ds_read_b128 v[162:165], v206 offset:8640
    ds_read_b128 v[166:169], v206 offset:8672
    v_mfma_f32_32x32x16_bf16 v[34:49], v[186:189], v[134:137], v[34:49]
    buffer_load_dwordx4 v203, s[16:19], s40 offen offset:1056 lds
    v_max3_f32 v214, v98, v99, v100
    v_max3_f32 v215, v101, v102, v103
    v_max3_f32 v214, v214, v104, v105
    v_max3_f32 v215, v215, v106, v107
    v_max3_f32 v214, v214, v108, v109
    v_mfma_f32_32x32x16_bf16 v[50:65], v[190:193], v[134:137], v[50:65]
    v_max3_f32 v215, v215, v110, v111
    v_max3_f32 v214, v214, v112, v113
    v_max_f32 v214, v214, v215
    v_cmp_gt_f32 vcc, v214, v211
    v_fma_f32 v114, v98, v229, -v210
    v_fma_f32 v115, v99, v229, -v210
    v_mfma_f32_32x32x16_bf16 v[66:81], v[194:197], v[134:137], v[66:81]
    v_fma_f32 v116, v100, v229, -v210
    v_fma_f32 v117, v101, v229, -v210
    v_fma_f32 v118, v102, v229, -v210
    v_fma_f32 v119, v103, v229, -v210
    v_fma_f32 v120, v104, v229, -v210
    v_fma_f32 v121, v105, v229, -v210
    v_mfma_f32_32x32x16_bf16 v[82:97], v[198:201], v[134:137], v[82:97]
    v_fma_f32 v122, v106, v229, -v210
    v_fma_f32 v123, v107, v229, -v210
    v_fma_f32 v124, v108, v229, -v210
    v_fma_f32 v125, v109, v229, -v210
    v_fma_f32 v126, v110, v229, -v210
    v_fma_f32 v127, v111, v229, -v210
    v_mfma_f32_16x16x32_bf16 v[244:247], v[240:243], v[134:137], v[244:247]
    v_fma_f32 v128, v112, v229, -v210
    v_fma_f32 v129, v113, v229, -v210
    s_sub_u32 s46, s46, 1
    s_cbranch_vccnz L_rare_s3
L_cont_s3:
    s_cbranch_scc0 L_steady0
L_e4:
    v_add_u32 v209, s63, v207
    v_add_u32 v239, s61, v206
    s_waitcnt lgkmcnt(0)
    v_mfma_f32_32x32x16_bf16 v[98:113], v[138:141], v[2:5], 0
    s_add_u32 m0, s62, s42
    ds_read_b64_tr_b16 v[170:171], v209 offset:0
    ds_read_b64_tr_b16 v[172:173], v209 offset:512
    ds_read_b64_tr_b16 v[174:175], v209 offset:64
    v_exp_f32 v220, v114
    v_mfma_f32_32x32x16_bf16 v[98:113], v[142:145], v[6:9], v[98:113]
    buffer_load_dwordx4 v204, s[20:23], s41 offen lds
    ds_read_b64_tr_b16 v[176:177], v209 offset:576
    ds_read_b64_tr_b16 v[178:179], v209 offset:128
    ds_read_b64_tr_b16 v[180:181], v209 offset:640
    v_exp_f32_e64 v221, v115
    v_mfma_f32_32x32x16_bf16 v[98:113], v[146:149], v[10:13], v[98:113]
    ds_read_b64_tr_b16 v[182:183], v209 offset:192
    ds_read_b64_tr_b16 v[184:185], v209 offset:704
    ds_read_b64_tr_b16 v[186:187], v209 offset:1024
    v_exp_f32_e64 v222, v116
    v_cvt_pk_bf16_f32 v130, v220, v221
    v_mfma_f32_32x32x16_bf16 v[98:113], v[150:153], v[14:17], v[98:113]
    ds_read_b64_tr_b16 v[188:189], v209 offset:1536
    ds_read_b64_tr_b16 v[190:191], v209 offset:1088
    v_exp_f32 v223, v117
    v_exp_f32 v224, v118
    v_mfma_f32_32x32x16_bf16 v[98:113], v[154:157], v[18:21], v[98:113]
    ds_read_b64_tr_b16 v[192:193], v209 offset:1600
    ds_read_b64_tr_b16 v[194:195], v209 offset:1152
    ds_read_b64_tr_b16 v[196:197], v209 offset:1664
    v_exp_f32_e64 v225, v119
    v_cvt_pk_bf16_f32 v131, v222, v223
    v_mfma_f32_32x32x16_bf16 v[98:113], v[158:161], v[22:25], v[98:113]
    buffer_load_dwordx4 v205, s[20:23], s41 offen offset:1024 lds
    ds_read_b64_tr_b16 v[198:199], v209 offset:1216
    ds_read_b64_tr_b16 v[200:201], v209 offset:1728
    v_exp_f32_e64 v226, v120
    v_cvt_pk_bf16_f32 v132, v224, v225
    v_mfma_f32_32x32x16_bf16 v[98:113], v[162:165], v[26:29], v[98:113]
    s_sub_u32 s41, s41, 0x8000
    v_exp_f32 v227, v121
    v_exp_f32 v220, v122
    v_cvt_pk_bf16_f32 v133, v226, v227
    v_mfma_f32_32x32x16_bf16 v[98:113], v[166:169], v[30:33], v[98:113]
    v_exp_f32 v221, v123
    v_exp_f32 v222, v124
    v_cvt_pk_bf16_f32 v134, v220, v221
    s_waitcnt vmcnt(8) lgkmcnt(0)
    v_mfma_f32_32x32x16_bf16 v[34:49], v[170:173], v[130:133], v[34:49]
    s_barrier
    v_exp_f32_e64 v223, v125
    v_mfma_f32_32x32x16_bf16 v[50:65], v[174:177], v[130:133], v[50:65]
    ds_read_b128 v[138:141], v239 offset:0
    ds_read_b128 v[142:145], v239 offset:32
    v_exp_f32_e64 v224, v126
    v_cvt_pk_bf16_f32 v135, v222, v223
    v_mfma_f32_32x32x16_bf16 v[66:81], v[178:181], v[130:133], v[66:81]
    ds_read_b128 v[146:149], v239 offset:64
    ds_read_b128 v[150:153], v239 offset:96
    v_exp_f32 v225, v127
    v_exp_f32 v226, v128
    v_mfma_f32_32x32x16_bf16 v[82:97], v[182:185], v[130:133], v[82:97]
    ds_read_b128 v[154:157], v239 offset:128
    ds_read_b128 v[158:161], v239 offset:160
    v_exp_f32_e64 v227, v129
    v_cvt_pk_bf16_f32 v136, v224, v225
    v_cvt_pk_bf16_f32 v137, v226, v227
    v_mfma_f32_16x16x32_bf16 v[244:247], v[240:243], v[130:133], v[244:247]
    ds_read_b128 v[162:165], v239 offset:192
    ds_read_b128 v[166:169], v239 offset:224
    v_mfma_f32_32x32x16_bf16 v[34:49], v[186:189], v[134:137], v[34:49]
    v_max3_f32 v214, v98, v99, v100
    v_max3_f32 v215, v101, v102, v103
    v_max3_f32 v214, v214, v104, v105
    v_max3_f32 v215, v215, v106, v107
    v_max3_f32 v214, v214, v108, v109
    v_mfma_f32_32x32x16_bf16 v[50:65], v[190:193], v[134:137], v[50:65]
    v_max3_f32 v215, v215, v110, v111
    v_max3_f32 v214, v214, v112, v113
    v_max_f32 v214, v214, v215
    v_cmp_gt_f32 vcc, v214, v211
    v_fma_f32 v114, v98, v229, -v210
    v_fma_f32 v115, v99, v229, -v210
    v_mfma_f32_32x32x16_bf16 v[66:81], v[194:197], v[134:137], v[66:81]
    v_fma_f32 v116, v100, v229, -v210
    v_fma_f32 v117, v101, v229, -v210
    v_fma_f32 v118, v102, v229, -v210
    v_fma_f32 v119, v103, v229, -v210
    v_fma_f32 v120, v104, v229, -v210
    v_fma_f32 v121, v105, v229, -v210
    v_mfma_f32_32x32x16_bf16 v[82:97], v[198:201], v[134:137], v[82:97]
    v_fma_f32 v122, v106, v229, -v210
    v_fma_f32 v123, v107, v229, -v210
    v_fma_f32 v124, v108, v229, -v210
    v_fma_f32 v125, v109, v229, -v210
    v_fma_f32 v126, v110, v229, -v210
    v_fma_f32 v127, v111, v229, -v210
    v_mfma_f32_16x16x32_bf16 v[244:247], v[240:243], v[134:137], v[244:247]
    v_fma_f32 v128, v112, v229, -v210
    v_fma_f32 v129, v113, v229, -v210
    s_cbranch_vccnz L_rare_e4
L_cont_e4:
L_e3:
    v_add_u32 v209, s60, v207
    v_add_u32 v239, s62, v206
    s_waitcnt lgkmcnt(0)
    v_mfma_f32_32x32x16_bf16 v[98:113], v[138:141], v[2:5], 0
    s_add_u32 m0, s63, s42
    ds_read_b64_tr_b16 v[170:171], v209 offset:0
    ds_read_b64_tr_b16 v[172:173], v209 offset:512
    ds_read_b64_tr_b16 v[174:175], v209 offset:64
    v_exp_f32 v220, v114
    v_mfma_f32_32x32x16_bf16 v[98:113], v[142:145], v[6:9], v[98:113]
    buffer_load_dwordx4 v204, s[20:23], s41 offen lds
    ds_read_b64_tr_b16 v[176:177], v209 offset:576
    ds_read_b64_tr_b16 v[178:179], v209 offset:128
    ds_read_b64_tr_b16 v[180:181], v209 offset:640
    v_exp_f32_e64 v221, v115
    v_mfma_f32_32x32x16_bf16 v[98:113], v[146:149], v[10:13], v[98:113]
    ds_read_b64_tr_b16 v[182:183], v209 offset:192
    ds_read_b64_tr_b16 v[184:185], v209 offset:704
    ds_read_b64_tr_b16 v[186:187], v209 offset:1024
    v_exp_f32_e64 v222, v116
    v_cvt_pk_bf16_f32 v130, v220, v221
    v_mfma_f32_32x32x16_bf16 v[98:113], v[150:153], v[14:17], v[98:113]
    ds_read_b64_tr_b16 v[188:189], v209 offset:1536
    ds_read_b64_tr_b16 v[190:191], v209 offset:1088
    v_exp_f32 v223, v117
    v_exp_f32 v224, v118
    v_mfma_f32_32x32x16_bf16 v[98:113], v[154:157], v[18:21], v[98:113]
    ds_read_b64_tr_b16 v[192:193], v209 offset:1600
    ds_read_b64_tr_b16 v[194:195], v209 offset:1152
    ds_read_b64_tr_b16 v[196:197], v209 offset:1664
    v_exp_f32_e64 v225, v119
    v_cvt_pk_bf16_f32 v131, v222, v223
    v_mfma_f32_32x32x16_bf16 v[98:113], v[158:161], v[22:25], v[98:113]
    buffer_load_dwordx4 v205, s[20:23], s41 offen offset:1024 lds
    ds_read_b64_tr_b16 v[198:199], v209 offset:1216
    ds_read_b64_tr_b16 v[200:201], v209 offset:1728
    v_exp_f32_e64 v226, v120
    v_cvt_pk_bf16_f32 v132, v224, v225
    v_mfma_f32_32x32x16_bf16 v[98:113], v[162:165], v[26:29], v[98:113]
    s_sub_u32 s41, s41, 0x8000
    v_exp_f32 v227, v121
    v_exp_f32 v220, v122
    v_cvt_pk_bf16_f32 v133, v226, v227
    v_mfma_f32_32x32x16_bf16 v[98:113], v[166:169], v[30:33], v[98:113]
    v_exp_f32 v221, v123
    v_exp_f32 v222, v124
    v_cvt_pk_bf16_f32 v134, v220, v221
    s_waitcnt vmcnt(6) lgkmcnt(0)
    v_mfma_f32_32x32x16_bf16 v[34:49], v[170:173], v[130:133], v[34:49]
    s_barrier
    v_exp_f32_e64 v223, v125
    v_mfma_f32_32x32x16_bf16 v[50:65], v[174:177], v[130:133], v[50:65]
    ds_read_b128 v[138:141], v239 offset:0
    ds_read_b128 v[142:145], v239 offset:32
    v_exp_f32_e64 v224, v126
    v_cvt_pk_bf16_f32 v135, v222, v223
    v_mfma_f32_32x32x16_bf16 v[66:81], v[178:181], v[130:133], v[66:81]
    ds_read_b128 v[146:149], v239 offset:64
    ds_read_b128 v[150:153], v239 offset:96
    v_exp_f32 v225, v127
    v_exp_f32 v226, v128
    v_mfma_f32_32x32x16_bf16 v[82:97], v[182:185], v[130:133], v[82:97]
    ds_read_b128 v[154:157], v239 offset:128
    ds_read_b128 v[158:161], v239 offset:160
    v_exp_f32_e64 v227, v129
    v_cvt_pk_bf16_f32 v136, v224, v225
    v_cvt_pk_bf16_f32 v137, v226, v227
    v_mfma_f32_16x16x32_bf16 v[244:247], v[240:243], v[130:133], v[244:247]
    ds_read_b128 v[162:165], v239 offset:192
    ds_read_b128 v[166:169], v239 offset:224
    v_mfma_f32_32x32x16_bf16 v[34:49], v[186:189], v[134:137], v[34:49]
    v_max3_f32 v214, v98, v99, v100
    v_max3_f32 v215, v101, v102, v103
    v_max3_f32 v214, v214, v104, v105
    v_max3_f32 v215, v215, v106, v107
    v_max3_f32 v214, v214, v108, v109
    v_mfma_f32_32x32x16_bf16 v[50:65], v[190:193], v[134:137], v[50:65]
    v_max3_f32 v215, v215, v110, v111
    v_max3_f32 v214, v214, v112, v113
    v_max_f32 v214, v214, v215
    v_cmp_gt_f32 vcc, v214, v211
    v_fma_f32 v114, v98, v229, -v210
    v_fma_f32 v115, v99, v229, -v210
    v_mfma_f32_32x32x16_bf16 v[66:81], v[194:197], v[134:137], v[66:81]
    v_fma_f32 v116, v100, v229, -v210
    v_fma_f32 v117, v101, v229, -v210
    v_fma_f32 v118, v102, v229, -v210
    v_fma_f32 v119, v103, v229, -v210
    v_fma_f32 v120, v104, v229, -v210
    v_fma_f32 v121, v105, v229, -v210
    v_mfma_f32_32x32x16_bf16 v[82:97], v[198:201], v[134:137], v[82:97]
    v_fma_f32 v122, v106, v229, -v210
    v_fma_f32 v123, v107, v229, -v210
    v_fma_f32 v124, v108, v229, -v210
    v_fma_f32 v125, v109, v229, -v210
    v_fma_f32 v126, v110, v229, -v210
    v_fma_f32 v127, v111, v229, -v210
    v_mfma_f32_16x16x32_bf16 v[244:247], v[240:243], v[134:137], v[244:247]
    v_fma_f32 v128, v112, v229, -v210
    v_fma_f32 v129, v113, v229, -v210
    s_cbranch_vccnz L_rare_e3
L_cont_e3:
L_e2:
    v_add_u32 v209, s61, v207
    v_add_u32 v239, s63, v206
    s_waitcnt lgkmcnt(0)
    v_mfma_f32_32x32x16_bf16 v[98:113], v[138:141], v[2:5], 0
    ds_read_b64_tr_b16 v[170:171], v209 offset:0
    ds_read_b64_tr_b16 v[172:173], v209 offset:512
    ds_read_b64_tr_b16 v[174:175], v209 offset:64
    v_exp_f32_e64 v220, v114
    v_mfma_f32_32x32x16_bf16 v[98:113], v[142:145], v[6:9], v[98:113]
    ds_read_b64_tr_b16 v[176:177], v209 offset:576
    ds_read_b64_tr_b16 v[178:179], v209 offset:128
    ds_read_b64_tr_b16 v[180:181], v209 offset:640
    v_exp_f32_e64 v221, v115
    v_mfma_f32_32x32x16_bf16 v[98:113], v[146:149], v[10:13], v[98:113]
    ds_read_b64_tr_b16 v[182:183], v209 offset:192
    ds_read_b64_tr_b16 v[184:185], v209 offset:704
    ds_read_b64_tr_b16 v[186:187], v209 offset:1024
    v_exp_f32_e64 v222, v116
    v_cvt_pk_bf16_f32 v130, v220, v221
    v_mfma_f32_32x32x16_bf16 v[98:113], v[150:153], v[14:17], v[98:113]
    ds_read_b64_tr_b16 v[188:189], v209 offset:1536
    ds_read_b64_tr_b16 v[190:191], v209 offset:1088
    v_exp_f32 v223, v117
    v_exp_f32 v224, v118
    v_mfma_f32_32x32x16_bf16 v[98:113], v[154:157], v[18:21], v[98:113]
    ds_read_b64_tr_b16 v[192:193], v209 offset:1600
    ds_read_b64_tr_b16 v[194:195], v209 offset:1152
    ds_read_b64_tr_b16 v[196:197], v209 offset:1664
    v_exp_f32_e64 v225, v119
    v_cvt_pk_bf16_f32 v131, v222, v223
    v_mfma_f32_32x32x16_bf16 v[98:113], v[158:161], v[22:25], v[98:113]
    ds_read_b64_tr_b16 v[198:199], v209 offset:1216
    ds_read_b64_tr_b16 v[200:201], v209 offset:1728
    v_exp_f32_e64 v226, v120
    v_cvt_pk_bf16_f32 v132, v224, v225
    v_mfma_f32_32x32x16_bf16 v[98:113], v[162:165], v[26:29], v[98:113]
    v_exp_f32 v227, v121
    v_exp_f32 v220, v122
    v_cvt_pk_bf16_f32 v133, v226, v227
    v_mfma_f32_32x32x16_bf16 v[98:113], v[166:169], v[30:33], v[98:113]
    v_exp_f32 v221, v123
    v_exp_f32 v222, v124
    v_cvt_pk_bf16_f32 v134, v220, v221
    s_waitcnt vmcnt(2) lgkmcnt(0)
    v_mfma_f32_32x32x16_bf16 v[34:49], v[170:173], v[130:133], v[34:49]
    s_barrier
    v_exp_f32_e64 v223, v125
    v_mfma_f32_32x32x16_bf16 v[50:65], v[174:177], v[130:133], v[50:65]
    ds_read_b128 v[138:141], v239 offset:0
    ds_read_b128 v[142:145], v239 offset:32
    v_exp_f32_e64 v224, v126
    v_cvt_pk_bf16_f32 v135, v222, v223
    v_mfma_f32_32x32x16_bf16 v[66:81], v[178:181], v[130:133], v[66:81]
    ds_read_b128 v[146:149], v239 offset:64
    ds_read_b128 v[150:153], v239 offset:96
    v_exp_f32 v225, v127
    v_exp_f32 v226, v128
    v_mfma_f32_32x32x16_bf16 v[82:97], v[182:185], v[130:133], v[82:97]
    ds_read_b128 v[154:157], v239 offset:128
    ds_read_b128 v[158:161], v239 offset:160
    v_exp_f32_e64 v227, v129
    v_cvt_pk_bf16_f32 v136, v224, v225
    v_cvt_pk_bf16_f32 v137, v226, v227
    v_mfma_f32_16x16x32_bf16 v[244:247], v[240:243], v[130:133], v[244:247]
    ds_read_b128 v[162:165], v239 offset:192
    ds_read_b128 v[166:169], v239 offset:224
    v_mfma_f32_32x32x16_bf16 v[34:49], v[186:189], v[134:137], v[34:49]
    v_max3_f32 v214, v98, v99, v100
    v_max3_f32 v215, v101, v102, v103
    v_max3_f32 v214, v214, v104, v105
    v_max3_f32 v215, v215, v106, v107
    v_max3_f32 v214, v214, v108, v109
    v_mfma_f32_32x32x16_bf16 v[50:65], v[190:193], v[134:137], v[50:65]
    v_max3_f32 v215, v215, v110, v111
    v_max3_f32 v214, v214, v112, v113
    v_max_f32 v214, v214, v215
    v_cmp_gt_f32 vcc, v214, v211
    v_fma_f32 v114, v98, v229, -v210
    v_fma_f32 v115, v99, v229, -v210
    v_mfma_f32_32x32x16_bf16 v[66:81], v[194:197], v[134:137], v[66:81]
    v_fma_f32 v116, v100, v229, -v210
    v_fma_f32 v117, v101, v229, -v210
    v_fma_f32 v118, v102, v229, -v210
    v_fma_f32 v119, v103, v229, -v210
    v_fma_f32 v120, v104, v229, -v210
    v_fma_f32 v121, v105, v229, -v210
    v_mfma_f32_32x32x16_bf16 v[82:97], v[198:201], v[134:137], v[82:97]
    v_fma_f32 v122, v106, v229, -v210
    v_fma_f32 v123, v107, v229, -v210
    v_fma_f32 v124, v108, v229, -v210
    v_fma_f32 v125, v109, v229, -v210
    v_fma_f32 v126, v110, v229, -v210
    v_fma_f32 v127, v111, v229, -v210
    v_mfma_f32_16x16x32_bf16 v[244:247], v[240:243], v[134:137], v[244:247]
    v_fma_f32 v128, v112, v229, -v210
    v_fma_f32 v129, v113, v229, -v210
    s_cbranch_vccnz L_rare_e2
L_cont_e2:
L_e1:
    v_add_u32 v209, s62, v207
    v_add_u32 v239, s60, v206
    s_waitcnt lgkmcnt(0)
    v_mfma_f32_32x32x16_bf16 v[98:113], v[138:141], v[2:5], 0
    ds_read_b64_tr_b16 v[170:171], v209 offset:0
    ds_read_b64_tr_b16 v[172:173], v209 offset:512
    ds_read_b64_tr_b16 v[174:175], v209 offset:64
    v_exp_f32_e64 v220, v114
    v_mfma_f32_32x32x16_bf16 v[98:113], v[142:145], v[6:9], v[98:113]
    ds_read_b64_tr_b16 v[176:177], v209 offset:576
    ds_read_b64_tr_b16 v[178:179], v209 offset:128
    ds_read_b64_tr_b16 v[180:181], v209 offset:640
    v_exp_f32_e64 v221, v115
    v_mfma_f32_32x32x16_bf16 v[98:113], v[146:149], v[10:13], v[98:113]
    ds_read_b64_tr_b16 v[182:183], v209 offset:192
    ds_read_b64_tr_b16 v[184:185], v209 offset:704
    ds_read_b64_tr_b16 v[186:187], v209 offset:1024
    v_exp_f32_e64 v222, v116
    v_cvt_pk_bf16_f32 v130, v220, v221
    v_mfma_f32_32x32x16_bf16 v[98:113], v[150:153], v[14:17], v[98:113]
    ds_read_b64_tr_b16 v[188:189], v209 offset:1536
    ds_read_b64_tr_b16 v[190:191], v209 offset:1088
    v_exp_f32 v223, v117
    v_exp_f32 v224, v118
    v_mfma_f32_32x32x16_bf16 v[98:113], v[154:157], v[18:21], v[98:113]
    ds_read_b64_tr_b16 v[192:193], v209 offset:1600
    ds_read_b64_tr_b16 v[194:195], v209 offset:1152
    ds_read_b64_tr_b16 v[196:197], v209 offset:1664
    v_exp_f32_e64 v225, v119
    v_cvt_pk_bf16_f32 v131, v222, v223
    v_mfma_f32_32x32x16_bf16 v[98:113], v[158:161], v[22:25], v[98:113]
    ds_read_b64_tr_b16 v[198:199], v209 offset:1216
    ds_read_b64_tr_b16 v[200:201], v209 offset:1728
    v_exp_f32_e64 v226, v120
    v_cvt_pk_bf16_f32 v132, v224, v225
    v_mfma_f32_32x32x16_bf16 v[98:113], v[162:165], v[26:29], v[98:113]
    v_exp_f32 v227, v121
    v_exp_f32 v220, v122
    v_cvt_pk_bf16_f32 v133, v226, v227
    v_mfma_f32_32x32x16_bf16 v[98:113], v[166:169], v[30:33], v[98:113]
    v_exp_f32 v221, v123
    v_exp_f32 v222, v124
    v_cvt_pk_bf16_f32 v134, v220, v221
    s_waitcnt vmcnt(0) lgkmcnt(0)
    v_mfma_f32_32x32x16_bf16 v[34:49], v[170:173], v[130:133], v[34:49]
    s_barrier
    v_exp_f32_e64 v223, v125
    v_mfma_f32_32x32x16_bf16 v[50:65], v[174:177], v[130:133], v[50:65]
    ds_read_b128 v[138:141], v239 offset:0
    ds_read_b128 v[142:145], v239 offset:32
    v_exp_f32_e64 v224, v126
    v_cvt_pk_bf16_f32 v135, v222, v223
    v_mfma_f32_32x32x16_bf16 v[66:81], v[178:181], v[130:133], v[66:81]
    ds_read_b128 v[146:149], v239 offset:64
    ds_read_b128 v[150:153], v239 offset:96
    v_exp_f32 v225, v127
    v_exp_f32 v226, v128
    v_mfma_f32_32x32x16_bf16 v[82:97], v[182:185], v[130:133], v[82:97]
    ds_read_b128 v[154:157], v239 offset:128
    ds_read_b128 v[158:161], v239 offset:160
    v_exp_f32_e64 v227, v129
    v_cvt_pk_bf16_f32 v136, v224, v225
    v_cvt_pk_bf16_f32 v137, v226, v227
    v_mfma_f32_16x16x32_bf16 v[244:247], v[240:243], v[130:133], v[244:247]
    ds_read_b128 v[162:165], v239 offset:192
    ds_read_b128 v[166:169], v239 offset:224
    v_mfma_f32_32x32x16_bf16 v[34:49], v[186:189], v[134:137], v[34:49]
    v_max3_f32 v214, v98, v99, v100
    v_max3_f32 v215, v101, v102, v103
    v_max3_f32 v214, v214, v104, v105
    v_max3_f32 v215, v215, v106, v107
    v_max3_f32 v214, v214, v108, v109
    v_mfma_f32_32x32x16_bf16 v[50:65], v[190:193], v[134:137], v[50:65]
    v_max3_f32 v215, v215, v110, v111
    v_max3_f32 v214, v214, v112, v113
    v_max_f32 v214, v214, v215
    v_cmp_gt_f32 vcc, v214, v211
    v_fma_f32 v114, v98, v229, -v210
    v_fma_f32 v115, v99, v229, -v210
    v_mfma_f32_32x32x16_bf16 v[66:81], v[194:197], v[134:137], v[66:81]
    v_fma_f32 v116, v100, v229, -v210
    v_fma_f32 v117, v101, v229, -v210
    v_fma_f32 v118, v102, v229, -v210
    v_fma_f32 v119, v103, v229, -v210
    v_fma_f32 v120, v104, v229, -v210
    v_fma_f32 v121, v105, v229, -v210
    v_mfma_f32_32x32x16_bf16 v[82:97], v[198:201], v[134:137], v[82:97]
    v_fma_f32 v122, v106, v229, -v210
    v_fma_f32 v123, v107, v229, -v210
    v_fma_f32 v124, v108, v229, -v210
    v_fma_f32 v125, v109, v229, -v210
    v_fma_f32 v126, v110, v229, -v210
    v_fma_f32 v127, v111, v229, -v210
    v_mfma_f32_16x16x32_bf16 v[244:247], v[240:243], v[134:137], v[244:247]
    v_fma_f32 v128, v112, v229, -v210
    v_fma_f32 v129, v113, v229, -v210
    s_cbranch_vccnz L_rare_e1
L_cont_e1:
L_tail:
    s_waitcnt lgkmcnt(0)
    s_bitcmp1_b32 s39, 2
    s_cbranch_scc0 L_tail_go
    ds_read_b128 v[2:5], v234 offset:0
    ds_read_b128 v[6:9], v234 offset:32
    ds_read_b128 v[10:13], v234 offset:64
    ds_read_b128 v[14:17], v234 offset:96
    ds_read_b128 v[18:21], v234 offset:128
    ds_read_b128 v[22:25], v234 offset:160
    ds_read_b128 v[26:29], v234 offset:192
    ds_read_b128 v[30:33], v234 offset:224
L_tail_go:
    ds_read_b64_tr_b16 v[170:171], v208 offset:0
    ds_read_b64_tr_b16 v[172:173], v208 offset:512
    ds_read_b64_tr_b16 v[174:175], v208 offset:64
    ds_read_b64_tr_b16 v[176:177], v208 offset:576
    ds_read_b64_tr_b16 v[178:179], v208 offset:128
    ds_read_b64_tr_b16 v[180:181], v208 offset:640
    ds_read_b64_tr_b16 v[182:183], v208 offset:192
    ds_read_b64_tr_b16 v[184:185], v208 offset:704
    ds_read_b64_tr_b16 v[186:187], v208 offset:1024
    ds_read_b64_tr_b16 v[188:189], v208 offset:1536
    ds_read_b64_tr_b16 v[190:191], v208 offset:1088
    ds_read_b64_tr_b16 v[192:193], v208 offset:1600
    ds_read_b64_tr_b16 v[194:195], v208 offset:1152
    ds_read_b64_tr_b16 v[196:197], v208 offset:1664
    ds_read_b64_tr_b16 v[198:199], v208 offset:1216
    ds_read_b64_tr_b16 v[200:201], v208 offset:1728
    v_exp_f32 v220, v114
    v_exp_f32 v221, v115
    v_exp_f32 v222, v116
    v_exp_f32 v223, v117
    v_cvt_pk_bf16_f32 v130, v220, v221
    v_exp_f32_e64 v224, v118
    v_cvt_pk_bf16_f32 v131, v222, v223
    v_exp_f32 v225, v119
    v_exp_f32 v226, v120
    v_exp_f32_e64 v227, v121
    v_cvt_pk_bf16_f32 v132, v224, v225
    v_exp_f32_e64 v220, v122
    v_cvt_pk_bf16_f32 v133, v226, v227
    s_waitcnt lgkmcnt(14)
    s_nop 0
    v_mfma_f32_32x32x16_bf16 v[34:49], v[170:173], v[130:133], v[34:49]
    v_exp_f32 v221, v123
    v_exp_f32 v222, v124
    v_cvt_pk_bf16_f32 v134, v220, v221
    s_waitcnt lgkmcnt(12)
    v_mfma_f32_32x32x16_bf16 v[50:65], v[174:177], v[130:133], v[50:65]
    v_exp_f32 v223, v125
    v_exp_f32_e64 v224, v126
    v_cvt_pk_bf16_f32 v135, v222, v223
    s_waitcnt lgkmcnt(10)
    v_mfma_f32_32x32x16_bf16 v[66:81], v[178:181], v[130:133], v[66:81]
    v_exp_f32 v225, v127
    v_exp_f32 v226, v128
    s_waitcnt lgkmcnt(8)
    v_mfma_f32_32x32x16_bf16 v[82:97], v[182:185], v[130:133], v[82:97]
    v_exp_f32_e64 v227, v129
    v_cvt_pk_bf16_f32 v136, v224, v225
    v_mfma_f32_16x16x32_bf16 v[244:247], v[240:243], v[130:133], v[244:247]
    v_cvt_pk_bf16_f32 v137, v226, v227
    s_nop 0
    s_nop 0
    v_mfma_f32_16x16x32_bf16 v[244:247], v[240:243], v[134:137], v[244:247]
    s_waitcnt lgkmcnt(6)
    v_mfma_f32_32x32x16_bf16 v[34:49], v[186:189], v[134:137], v[34:49]
    s_waitcnt lgkmcnt(4)
    v_mfma_f32_32x32x16_bf16 v[50:65], v[190:193], v[134:137], v[50:65]
    s_waitcnt lgkmcnt(2)
    v_mfma_f32_32x32x16_bf16 v[66:81], v[194:197], v[134:137], v[66:81]
    s_nop 1
    v_permlane16_swap_b32 v244, v245
    v_mov_b32 v216, v244
    s_waitcnt lgkmcnt(0)
    v_mfma_f32_32x32x16_bf16 v[82:97], v[198:201], v[134:137], v[82:97]
    v_permlane32_swap_b32 v244, v216
    v_rcp_f32 v218, v244
    s_barrier
    v_mov_b32_e64 v219, v218
    v_pk_mul_f32 v[34:35], v[34:35], v[218:219]
    v_pk_mul_f32 v[36:37], v[36:37], v[218:219]
    v_pk_mul_f32 v[38:39], v[38:39], v[218:219]
    v_pk_mul_f32 v[40:41], v[40:41], v[218:219]
    v_pk_mul_f32 v[42:43], v[42:43], v[218:219]
    v_pk_mul_f32 v[44:45], v[44:45], v[218:219]
    v_pk_mul_f32 v[46:47], v[46:47], v[218:219]
    v_pk_mul_f32 v[48:49], v[48:49], v[218:219]
    v_cvt_pk_bf16_f32 v138, v34, v35
    v_cvt_pk_bf16_f32 v139, v36, v37
    v_cvt_pk_bf16_f32 v140, v38, v39
    v_cvt_pk_bf16_f32 v141, v40, v41
    v_cvt_pk_bf16_f32 v142, v42, v43
    v_cvt_pk_bf16_f32 v143, v44, v45
    v_cvt_pk_bf16_f32 v144, v46, v47
    v_cvt_pk_bf16_f32 v145, v48, v49
    ds_write_b128 v236, v[138:141] offset:0
    ds_write_b128 v236, v[142:145] offset:32
    v_pk_mul_f32 v[50:51], v[50:51], v[218:219]
    v_pk_mul_f32 v[52:53], v[52:53], v[218:219]
    v_pk_mul_f32 v[54:55], v[54:55], v[218:219]
    v_pk_mul_f32 v[56:57], v[56:57], v[218:219]
    v_pk_mul_f32 v[58:59], v[58:59], v[218:219]
    v_pk_mul_f32 v[60:61], v[60:61], v[218:219]
    v_pk_mul_f32 v[62:63], v[62:63], v[218:219]
    v_pk_mul_f32 v[64:65], v[64:65], v[218:219]
    v_cvt_pk_bf16_f32 v146, v50, v51
    v_cvt_pk_bf16_f32 v147, v52, v53
    v_cvt_pk_bf16_f32 v148, v54, v55
    v_cvt_pk_bf16_f32 v149, v56, v57
    v_cvt_pk_bf16_f32 v150, v58, v59
    v_cvt_pk_bf16_f32 v151, v60, v61
    v_cvt_pk_bf16_f32 v152, v62, v63
    v_cvt_pk_bf16_f32 v153, v64, v65
    ds_write_b128 v236, v[146:149] offset:64
    ds_write_b128 v236, v[150:153] offset:96
    ds_read_b128 v[170:173], v237 offset:0
    ds_read_b128 v[174:177], v237 offset:2176
    ds_read_b128 v[178:181], v237 offset:4352
    ds_read_b128 v[182:185], v237 offset:6528
    v_pk_mul_f32 v[66:67], v[66:67], v[218:219]
    v_pk_mul_f32 v[68:69], v[68:69], v[218:219]
    v_pk_mul_f32 v[70:71], v[70:71], v[218:219]
    v_pk_mul_f32 v[72:73], v[72:73], v[218:219]
    v_pk_mul_f32 v[74:75], v[74:75], v[218:219]
    v_pk_mul_f32 v[76:77], v[76:77], v[218:219]
    v_pk_mul_f32 v[78:79], v[78:79], v[218:219]
    v_pk_mul_f32 v[80:81], v[80:81], v[218:219]
    v_cvt_pk_bf16_f32 v154, v66, v67
    v_cvt_pk_bf16_f32 v155, v68, v69
    v_cvt_pk_bf16_f32 v156, v70, v71
    v_cvt_pk_bf16_f32 v157, v72, v73
    v_cvt_pk_bf16_f32 v158, v74, v75
    v_cvt_pk_bf16_f32 v159, v76, v77
    v_cvt_pk_bf16_f32 v160, v78, v79
    v_cvt_pk_bf16_f32 v161, v80, v81
    ds_write_b128 v236, v[154:157] offset:128
    ds_write_b128 v236, v[158:161] offset:160
    s_waitcnt lgkmcnt(5)
    buffer_store_dwordx4 v[170:173], v250, s[24:27], 0 offen nt
    s_waitcnt lgkmcnt(4)
    buffer_store_dwordx4 v[174:177], v251, s[24:27], 0 offen nt
    s_waitcnt lgkmcnt(3)
    buffer_store_dwordx4 v[178:181], v252, s[24:27], 0 offen nt
    s_waitcnt lgkmcnt(2)
    buffer_store_dwordx4 v[182:185], v253, s[24:27], 0 offen nt
    v_pk_mul_f32 v[82:83], v[82:83], v[218:219]
    v_pk_mul_f32 v[84:85], v[84:85], v[218:219]
    v_pk_mul_f32 v[86:87], v[86:87], v[218:219]
    v_pk_mul_f32 v[88:89], v[88:89], v[218:219]
    v_pk_mul_f32 v[90:91], v[90:91], v[218:219]
    v_pk_mul_f32 v[92:93], v[92:93], v[218:219]
    v_pk_mul_f32 v[94:95], v[94:95], v[218:219]
    v_pk_mul_f32 v[96:97], v[96:97], v[218:219]
    v_cvt_pk_bf16_f32 v162, v82, v83
    v_cvt_pk_bf16_f32 v163, v84, v85
    v_cvt_pk_bf16_f32 v164, v86, v87
    v_cvt_pk_bf16_f32 v165, v88, v89
    v_cvt_pk_bf16_f32 v166, v90, v91
    v_cvt_pk_bf16_f32 v167, v92, v93
    v_cvt_pk_bf16_f32 v168, v94, v95
    v_cvt_pk_bf16_f32 v169, v96, v97
    ds_write_b128 v236, v[162:165] offset:192
    ds_write_b128 v236, v[166:169] offset:224
    ds_read_b128 v[186:189], v237 offset:128
    ds_read_b128 v[190:193], v237 offset:2304
    ds_read_b128 v[194:197], v237 offset:4480
    ds_read_b128 v[198:201], v237 offset:6656
    s_waitcnt lgkmcnt(3)
    buffer_store_dwordx4 v[186:189], v250, s[24:27], 0 offen offset:128 nt
    s_waitcnt lgkmcnt(2)
    buffer_store_dwordx4 v[190:193], v251, s[24:27], 0 offen offset:128 nt
    s_waitcnt lgkmcnt(1)
    buffer_store_dwordx4 v[194:197], v252, s[24:27], 0 offen offset:128 nt
    s_waitcnt lgkmcnt(0)
    buffer_store_dwordx4 v[198:201], v253, s[24:27], 0 offen offset:128 nt
    s_bitcmp1_b32 s39, 2
    s_cbranch_scc1 L_follow
    s_endpgm
L_follow:
    s_bitset0_b32 s39, 2
    s_sub_u32 s24, s24, 0x20000
    s_subb_u32 s25, s25, 0
    s_nop 0
    ds_read_b128 v[138:141], v206 offset:8448
    ds_read_b128 v[142:145], v206 offset:8480
    ds_read_b128 v[146:149], v206 offset:8512
    ds_read_b128 v[150:153], v206 offset:8544
    ds_read_b128 v[154:157], v206 offset:8576
    ds_read_b128 v[158:161], v206 offset:8608
    ds_read_b128 v[162:165], v206 offset:8640
    ds_read_b128 v[166:169], v206 offset:8672
    v_cmp_gt_i32 s[64:65], 0, v232
    v_cmp_gt_i32 s[66:67], 1, v232
    v_cmp_gt_i32 s[68:69], 2, v232
    v_cmp_gt_i32 s[70:71], 3, v232
    v_cndmask_b32 v98, 0, v230, s[64:65]
    v_cndmask_b32 v99, 0, v230, s[66:67]
    v_cndmask_b32 v100, 0, v230, s[68:69]
    v_cndmask_b32 v101, 0, v230, s[70:71]
    v_cmp_gt_i32 s[64:65], 8, v232
    v_cmp_gt_i32 s[66:67], 9, v232
    v_cmp_gt_i32 s[68:69], 10, v232
    v_cmp_gt_i32 s[70:71], 11, v232
    v_cndmask_b32 v102, 0, v230, s[64:65]
    v_cndmask_b32 v103, 0, v230, s[66:67]
    v_cndmask_b32 v104, 0, v230, s[68:69]
    v_cndmask_b32 v105, 0, v230, s[70:71]
    v_cmp_gt_i32 s[64:65], 16, v232
    v_cmp_gt_i32 s[66:67], 17, v232
    v_cmp_gt_i32 s[68:69], 18, v232
    v_cmp_gt_i32 s[70:71], 19, v232
    v_cndmask_b32 v106, 0, v230, s[64:65]
    v_cndmask_b32 v107, 0, v230, s[66:67]
    v_cndmask_b32 v108, 0, v230, s[68:69]
    v_cndmask_b32 v109, 0, v230, s[70:71]
    v_cmp_gt_i32 s[64:65], 24, v232
    v_cmp_gt_i32 s[66:67], 25, v232
    v_cmp_gt_i32 s[68:69], 26, v232
    v_cmp_gt_i32 s[70:71], 27, v232
    v_cndmask_b32 v110, 0, v230, s[64:65]
    v_cndmask_b32 v111, 0, v230, s[66:67]
    v_cndmask_b32 v112, 0, v230, s[68:69]
    v_cndmask_b32 v113, 0, v230, s[70:71]
    v_mov_b32 v244, 0
    v_mov_b32 v245, 0
    v_mov_b32 v246, 0
    v_mov_b32 v247, 0
    v_mov_b32 v130, 0
    v_mov_b32 v131, 0
    v_mov_b32 v132, 0
    v_mov_b32 v133, 0
    s_waitcnt lgkmcnt(0)
    s_nop 0
    v_mfma_f32_32x32x16_bf16 v[98:113], v[138:141], v[2:5], v[98:113]
    v_mfma_f32_32x32x16_bf16 v[98:113], v[142:145], v[6:9], v[98:113]
    v_mfma_f32_32x32x16_bf16 v[98:113], v[146:149], v[10:13], v[98:113]
    v_mfma_f32_32x32x16_bf16 v[98:113], v[150:153], v[14:17], v[98:113]
    v_mfma_f32_32x32x16_bf16 v[98:113], v[154:157], v[18:21], v[98:113]
    v_mfma_f32_32x32x16_bf16 v[98:113], v[158:161], v[22:25], v[98:113]
    v_mfma_f32_32x32x16_bf16 v[98:113], v[162:165], v[26:29], v[98:113]
    v_mfma_f32_32x32x16_bf16 v[98:113], v[166:169], v[30:33], v[98:113]
    v_mfma_f32_32x32x16_bf16 v[34:49], v[130:133], v[130:133], 0
    v_mfma_f32_32x32x16_bf16 v[50:65], v[130:133], v[130:133], 0
    v_mfma_f32_32x32x16_bf16 v[66:81], v[130:133], v[130:133], 0
    v_mfma_f32_32x32x16_bf16 v[82:97], v[130:133], v[130:133], 0
    s_nop 7
    s_nop 0
    v_max3_f32 v214, v98, v99, v100
    v_max3_f32 v215, v101, v102, v103
    v_max3_f32 v214, v214, v104, v105
    v_max3_f32 v215, v215, v106, v107
    v_max3_f32 v214, v214, v108, v109
    v_max3_f32 v215, v215, v110, v111
    v_max3_f32 v214, v214, v112, v113
    v_max_f32 v214, v214, v215
    v_mov_b32 v216, v214
    s_nop 1
    v_permlane32_swap_b32 v214, v216
    v_max_f32 v214, v214, v216
    v_mov_b32 v228, v214
    v_mul_f32_e64 v210, v229, v214
    v_fma_f32 v114, v98, v229, -v210
    v_fma_f32 v115, v99, v229, -v210
    v_fma_f32 v116, v100, v229, -v210
    v_fma_f32 v117, v101, v229, -v210
    v_fma_f32 v118, v102, v229, -v210
    v_fma_f32 v119, v103, v229, -v210
    v_fma_f32 v120, v104, v229, -v210
    v_fma_f32 v121, v105, v229, -v210
    v_fma_f32 v122, v106, v229, -v210
    v_fma_f32 v123, v107, v229, -v210
    v_fma_f32 v124, v108, v229, -v210
    v_fma_f32 v125, v109, v229, -v210
    v_fma_f32 v126, v110, v229, -v210
    v_fma_f32 v127, v111, v229, -v210
    v_fma_f32 v128, v112, v229, -v210
    v_fma_f32 v129, v113, v229, -v210
    s_branch L_tail
L_rare_s0:
    v_mov_b32 v216, v214
    s_nop 1
    v_permlane32_swap_b32 v214, v216
    v_max_f32 v214, v214, v216
    v_max_f32 v214, v214, v228
    v_sub_f32 v217, v228, v214
    v_mul_f32 v217, v229, v217
    v_exp_f32 v217, v217
    v_mov_b32 v228, v214
    v_mul_f32 v210, v229, v214
    v_add_f32 v211, s47, v214
    v_fma_f32 v114, v98, v229, -v210
    v_fma_f32 v115, v99, v229, -v210
    v_fma_f32 v116, v100, v229, -v210
    v_fma_f32 v117, v101, v229, -v210
    v_fma_f32 v118, v102, v229, -v210
    v_fma_f32 v119, v103, v229, -v210
    v_fma_f32 v120, v104, v229, -v210
    v_fma_f32 v121, v105, v229, -v210
    v_fma_f32 v122, v106, v229, -v210
    v_fma_f32 v123, v107, v229, -v210
    v_fma_f32 v124, v108, v229, -v210
    v_fma_f32 v125, v109, v229, -v210
    v_fma_f32 v126, v110, v229, -v210
    v_fma_f32 v127, v111, v229, -v210
    v_fma_f32 v128, v112, v229, -v210
    v_fma_f32 v129, v113, v229, -v210
    v_mov_b32 v218, v217
    v_mov_b32 v219, v217
    s_nop 1
    v_permlane16_swap_b32 v218, v219
    v_mul_f32 v244, v244, v217
    v_mul_f32 v245, v245, v219
    v_mul_f32 v34, v34, v217
    v_mul_f32 v35, v35, v217
    v_mul_f32 v36, v36, v217
    v_mul_f32 v37, v37, v217
    v_mul_f32 v38, v38, v217
    v_mul_f32 v39, v39, v217
    v_mul_f32 v40, v40, v217
    v_mul_f32 v41, v41, v217
    v_mul_f32 v42, v42, v217
    v_mul_f32 v43, v43, v217
    v_mul_f32 v44, v44, v217
    v_mul_f32 v45, v45, v217
    v_mul_f32 v46, v46, v217
    v_mul_f32 v47, v47, v217
    v_mul_f32 v48, v48, v217
    v_mul_f32 v49, v49, v217
    v_mul_f32 v50, v50, v217
    v_mul_f32 v51, v51, v217
    v_mul_f32 v52, v52, v217
    v_mul_f32 v53, v53, v217
    v_mul_f32 v54, v54, v217
    v_mul_f32 v55, v55, v217
    v_mul_f32 v56, v56, v217
    v_mul_f32 v57, v57, v217
    v_mul_f32 v58, v58, v217
    v_mul_f32 v59, v59, v217
    v_mul_f32 v60, v60, v217
    v_mul_f32 v61, v61, v217
    v_mul_f32 v62, v62, v217
    v_mul_f32 v63, v63, v217
    v_mul_f32 v64, v64, v217
    v_mul_f32 v65, v65, v217
    v_mul_f32 v66, v66, v217
    v_mul_f32 v67, v67, v217
    v_mul_f32 v68, v68, v217
    v_mul_f32 v69, v69, v217
    v_mul_f32 v70, v70, v217
    v_mul_f32 v71, v71, v217
    v_mul_f32 v72, v72, v217
    v_mul_f32 v73, v73, v217
    v_mul_f32 v74, v74, v217
    v_mul_f32 v75, v75, v217
    v_mul_f32 v76, v76, v217
    v_mul_f32 v77, v77, v217
    v_mul_f32 v78, v78, v217
    v_mul_f32 v79, v79, v217
    v_mul_f32 v80, v80, v217
    v_mul_f32 v81, v81, v217
    v_mul_f32 v82, v82, v217
    v_mul_f32 v83, v83, v217
    v_mul_f32 v84, v84, v217
    v_mul_f32 v85, v85, v217
    v_mul_f32 v86, v86, v217
    v_mul_f32 v87, v87, v217
    v_mul_f32 v88, v88, v217
    v_mul_f32 v89, v89, v217
    v_mul_f32 v90, v90, v217
    v_mul_f32 v91, v91, v217
    v_mul_f32 v92, v92, v217
    v_mul_f32 v93, v93, v217
    v_mul_f32 v94, v94, v217
    v_mul_f32 v95, v95, v217
    v_mul_f32 v96, v96, v217
    v_mul_f32 v97, v97, v217
    s_nop 1
    s_branch L_cont_s0
L_rare_s1:
    v_mov_b32 v216, v214
    s_nop 1
    v_permlane32_swap_b32 v214, v216
    v_max_f32 v214, v214, v216
    v_max_f32 v214, v214, v228
    v_sub_f32 v217, v228, v214
    v_mul_f32 v217, v229, v217
    v_exp_f32 v217, v217
    v_mov_b32 v228, v214
    v_mul_f32 v210, v229, v214
    v_add_f32 v211, s47, v214
    v_fma_f32 v114, v98, v229, -v210
    v_fma_f32 v115, v99, v229, -v210
    v_fma_f32 v116, v100, v229, -v210
    v_fma_f32 v117, v101, v229, -v210
    v_fma_f32 v118, v102, v229, -v210
    v_fma_f32 v119, v103, v229, -v210
    v_fma_f32 v120, v104, v229, -v210
    v_fma_f32 v121, v105, v229, -v210
    v_fma_f32 v122, v106, v229, -v210
    v_fma_f32 v123, v107, v229, -v210
    v_fma_f32 v124, v108, v229, -v210
    v_fma_f32 v125, v109, v229, -v210
    v_fma_f32 v126, v110, v229, -v210
    v_fma_f32 v127, v111, v229, -v210
    v_fma_f32 v128, v112, v229, -v210
    v_fma_f32 v129, v113, v229, -v210
    v_mov_b32 v218, v217
    v_mov_b32 v219, v217
    s_nop 1
    v_permlane16_swap_b32 v218, v219
    v_mul_f32 v244, v244, v217
    v_mul_f32 v245, v245, v219
    v_mul_f32 v34, v34, v217
    v_mul_f32 v35, v35, v217
    v_mul_f32 v36, v36, v217
    v_mul_f32 v37, v37, v217
    v_mul_f32 v38, v38, v217
    v_mul_f32 v39, v39, v217
    v_mul_f32 v40, v40, v217
    v_mul_f32 v41, v41, v217
    v_mul_f32 v42, v42, v217
    v_mul_f32 v43, v43, v217
    v_mul_f32 v44, v44, v217
    v_mul_f32 v45, v45, v217
    v_mul_f32 v46, v46, v217
    v_mul_f32 v47, v47, v217
    v_mul_f32 v48, v48, v217
    v_mul_f32 v49, v49, v217
    v_mul_f32 v50, v50, v217
    v_mul_f32 v51, v51, v217
    v_mul_f32 v52, v52, v217
    v_mul_f32 v53, v53, v217
    v_mul_f32 v54, v54, v217
    v_mul_f32 v55, v55, v217
    v_mul_f32 v56, v56, v217
    v_mul_f32 v57, v57, v217
    v_mul_f32 v58, v58, v217
    v_mul_f32 v59, v59, v217
    v_mul_f32 v60, v60, v217
    v_mul_f32 v61, v61, v217
    v_mul_f32 v62, v62, v217
    v_mul_f32 v63, v63, v217
    v_mul_f32 v64, v64, v217
    v_mul_f32 v65, v65, v217
    v_mul_f32 v66, v66, v217
    v_mul_f32 v67, v67, v217
    v_mul_f32 v68, v68, v217
    v_mul_f32 v69, v69, v217
    v_mul_f32 v70, v70, v217
    v_mul_f32 v71, v71, v217
    v_mul_f32 v72, v72, v217
    v_mul_f32 v73, v73, v217
    v_mul_f32 v74, v74, v217
    v_mul_f32 v75, v75, v217
    v_mul_f32 v76, v76, v217
    v_mul_f32 v77, v77, v217
    v_mul_f32 v78, v78, v217
    v_mul_f32 v79, v79, v217
    v_mul_f32 v80, v80, v217
    v_mul_f32 v81, v81, v217
    v_mul_f32 v82, v82, v217
    v_mul_f32 v83, v83, v217
    v_mul_f32 v84, v84, v217
    v_mul_f32 v85, v85, v217
    v_mul_f32 v86, v86, v217
    v_mul_f32 v87, v87, v217
    v_mul_f32 v88, v88, v217
    v_mul_f32 v89, v89, v217
    v_mul_f32 v90, v90, v217
    v_mul_f32 v91, v91, v217
    v_mul_f32 v92, v92, v217
    v_mul_f32 v93, v93, v217
    v_mul_f32 v94, v94, v217
    v_mul_f32 v95, v95, v217
    v_mul_f32 v96, v96, v217
    v_mul_f32 v97, v97, v217
    s_nop 1
    s_branch L_cont_s1
L_rare_s2:
    v_mov_b32 v216, v214
    s_nop 1
    v_permlane32_swap_b32 v214, v216
    v_max_f32 v214, v214, v216
    v_max_f32 v214, v214, v228
    v_sub_f32 v217, v228, v214
    v_mul_f32 v217, v229, v217
    v_exp_f32 v217, v217
    v_mov_b32 v228, v214
    v_mul_f32 v210, v229, v214
    v_add_f32 v211, s47, v214
    v_fma_f32 v114, v98, v229, -v210
    v_fma_f32 v115, v99, v229, -v210
    v_fma_f32 v116, v100, v229, -v210
    v_fma_f32 v117, v101, v229, -v210
    v_fma_f32 v118, v102, v229, -v210
    v_fma_f32 v119, v103, v229, -v210
    v_fma_f32 v120, v104, v229, -v210
    v_fma_f32 v121, v105, v229, -v210
    v_fma_f32 v122, v106, v229, -v210
    v_fma_f32 v123, v107, v229, -v210
    v_fma_f32 v124, v108, v229, -v210
    v_fma_f32 v125, v109, v229, -v210
    v_fma_f32 v126, v110, v229, -v210
    v_fma_f32 v127, v111, v229, -v210
    v_fma_f32 v128, v112, v229, -v210
    v_fma_f32 v129, v113, v229, -v210
    v_mov_b32 v218, v217
    v_mov_b32 v219, v217
    s_nop 1
    v_permlane16_swap_b32 v218, v219
    v_mul_f32 v244, v244, v217
    v_mul_f32 v245, v245, v219
    v_mul_f32 v34, v34, v217
    v_mul_f32 v35, v35, v217
    v_mul_f32 v36, v36, v217
    v_mul_f32 v37, v37, v217
    v_mul_f32 v38, v38, v217
    v_mul_f32 v39, v39, v217
    v_mul_f32 v40, v40, v217
    v_mul_f32 v41, v41, v217
    v_mul_f32 v42, v42, v217
    v_mul_f32 v43, v43, v217
    v_mul_f32 v44, v44, v217
    v_mul_f32 v45, v45, v217
    v_mul_f32 v46, v46, v217
    v_mul_f32 v47, v47, v217
    v_mul_f32 v48, v48, v217
    v_mul_f32 v49, v49, v217
    v_mul_f32 v50, v50, v217
    v_mul_f32 v51, v51, v217
    v_mul_f32 v52, v52, v217
    v_mul_f32 v53, v53, v217
    v_mul_f32 v54, v54, v217
    v_mul_f32 v55, v55, v217
    v_mul_f32 v56, v56, v217
    v_mul_f32 v57, v57, v217
    v_mul_f32 v58, v58, v217
    v_mul_f32 v59, v59, v217
    v_mul_f32 v60, v60, v217
    v_mul_f32 v61, v61, v217
    v_mul_f32 v62, v62, v217
    v_mul_f32 v63, v63, v217
    v_mul_f32 v64, v64, v217
    v_mul_f32 v65, v65, v217
    v_mul_f32 v66, v66, v217
    v_mul_f32 v67, v67, v217
    v_mul_f32 v68, v68, v217
    v_mul_f32 v69, v69, v217
    v_mul_f32 v70, v70, v217
    v_mul_f32 v71, v71, v217
    v_mul_f32 v72, v72, v217
    v_mul_f32 v73, v73, v217
    v_mul_f32 v74, v74, v217
    v_mul_f32 v75, v75, v217
    v_mul_f32 v76, v76, v217
    v_mul_f32 v77, v77, v217
    v_mul_f32 v78, v78, v217
    v_mul_f32 v79, v79, v217
    v_mul_f32 v80, v80, v217
    v_mul_f32 v81, v81, v217
    v_mul_f32 v82, v82, v217
    v_mul_f32 v83, v83, v217
    v_mul_f32 v84, v84, v217
    v_mul_f32 v85, v85, v217
    v_mul_f32 v86, v86, v217
    v_mul_f32 v87, v87, v217
    v_mul_f32 v88, v88, v217
    v_mul_f32 v89, v89, v217
    v_mul_f32 v90, v90, v217
    v_mul_f32 v91, v91, v217
    v_mul_f32 v92, v92, v217
    v_mul_f32 v93, v93, v217
    v_mul_f32 v94, v94, v217
    v_mul_f32 v95, v95, v217
    v_mul_f32 v96, v96, v217
    v_mul_f32 v97, v97, v217
    s_nop 1
    s_branch L_cont_s2
L_rare_s3:
    v_mov_b32 v216, v214
    s_nop 1
    v_permlane32_swap_b32 v214, v216
    v_max_f32 v214, v214, v216
    v_max_f32 v214, v214, v228
    v_sub_f32 v217, v228, v214
    v_mul_f32 v217, v229, v217
    v_exp_f32 v217, v217
    v_mov_b32 v228, v214
    v_mul_f32 v210, v229, v214
    v_add_f32 v211, s47, v214
    v_fma_f32 v114, v98, v229, -v210
    v_fma_f32 v115, v99, v229, -v210
    v_fma_f32 v116, v100, v229, -v210
    v_fma_f32 v117, v101, v229, -v210
    v_fma_f32 v118, v102, v229, -v210
    v_fma_f32 v119, v103, v229, -v210
    v_fma_f32 v120, v104, v229, -v210
    v_fma_f32 v121, v105, v229, -v210
    v_fma_f32 v122, v106, v229, -v210
    v_fma_f32 v123, v107, v229, -v210
    v_fma_f32 v124, v108, v229, -v210
    v_fma_f32 v125, v109, v229, -v210
    v_fma_f32 v126, v110, v229, -v210
    v_fma_f32 v127, v111, v229, -v210
    v_fma_f32 v128, v112, v229, -v210
    v_fma_f32 v129, v113, v229, -v210
    v_mov_b32 v218, v217
    v_mov_b32 v219, v217
    s_nop 1
    v_permlane16_swap_b32 v218, v219
    v_mul_f32 v244, v244, v217
    v_mul_f32 v245, v245, v219
    v_mul_f32 v34, v34, v217
    v_mul_f32 v35, v35, v217
    v_mul_f32 v36, v36, v217
    v_mul_f32 v37, v37, v217
    v_mul_f32 v38, v38, v217
    v_mul_f32 v39, v39, v217
    v_mul_f32 v40, v40, v217
    v_mul_f32 v41, v41, v217
    v_mul_f32 v42, v42, v217
    v_mul_f32 v43, v43, v217
    v_mul_f32 v44, v44, v217
    v_mul_f32 v45, v45, v217
    v_mul_f32 v46, v46, v217
    v_mul_f32 v47, v47, v217
    v_mul_f32 v48, v48, v217
    v_mul_f32 v49, v49, v217
    v_mul_f32 v50, v50, v217
    v_mul_f32 v51, v51, v217
    v_mul_f32 v52, v52, v217
    v_mul_f32 v53, v53, v217
    v_mul_f32 v54, v54, v217
    v_mul_f32 v55, v55, v217
    v_mul_f32 v56, v56, v217
    v_mul_f32 v57, v57, v217
    v_mul_f32 v58, v58, v217
    v_mul_f32 v59, v59, v217
    v_mul_f32 v60, v60, v217
    v_mul_f32 v61, v61, v217
    v_mul_f32 v62, v62, v217
    v_mul_f32 v63, v63, v217
    v_mul_f32 v64, v64, v217
    v_mul_f32 v65, v65, v217
    v_mul_f32 v66, v66, v217
    v_mul_f32 v67, v67, v217
    v_mul_f32 v68, v68, v217
    v_mul_f32 v69, v69, v217
    v_mul_f32 v70, v70, v217
    v_mul_f32 v71, v71, v217
    v_mul_f32 v72, v72, v217
    v_mul_f32 v73, v73, v217
    v_mul_f32 v74, v74, v217
    v_mul_f32 v75, v75, v217
    v_mul_f32 v76, v76, v217
    v_mul_f32 v77, v77, v217
    v_mul_f32 v78, v78, v217
    v_mul_f32 v79, v79, v217
    v_mul_f32 v80, v80, v217
    v_mul_f32 v81, v81, v217
    v_mul_f32 v82, v82, v217
    v_mul_f32 v83, v83, v217
    v_mul_f32 v84, v84, v217
    v_mul_f32 v85, v85, v217
    v_mul_f32 v86, v86, v217
    v_mul_f32 v87, v87, v217
    v_mul_f32 v88, v88, v217
    v_mul_f32 v89, v89, v217
    v_mul_f32 v90, v90, v217
    v_mul_f32 v91, v91, v217
    v_mul_f32 v92, v92, v217
    v_mul_f32 v93, v93, v217
    v_mul_f32 v94, v94, v217
    v_mul_f32 v95, v95, v217
    v_mul_f32 v96, v96, v217
    v_mul_f32 v97, v97, v217
    s_nop 1
    s_branch L_cont_s3
L_rare_e4:
    v_mov_b32 v216, v214
    s_nop 1
    v_permlane32_swap_b32 v214, v216
    v_max_f32 v214, v214, v216
    v_max_f32 v214, v214, v228
    v_sub_f32 v217, v228, v214
    v_mul_f32 v217, v229, v217
    v_exp_f32 v217, v217
    v_mov_b32 v228, v214
    v_mul_f32 v210, v229, v214
    v_add_f32 v211, s47, v214
    v_fma_f32 v114, v98, v229, -v210
    v_fma_f32 v115, v99, v229, -v210
    v_fma_f32 v116, v100, v229, -v210
    v_fma_f32 v117, v101, v229, -v210
    v_fma_f32 v118, v102, v229, -v210
    v_fma_f32 v119, v103, v229, -v210
    v_fma_f32 v120, v104, v229, -v210
    v_fma_f32 v121, v105, v229, -v210
    v_fma_f32 v122, v106, v229, -v210
    v_fma_f32 v123, v107, v229, -v210
    v_fma_f32 v124, v108, v229, -v210
    v_fma_f32 v125, v109, v229, -v210
    v_fma_f32 v126, v110, v229, -v210
    v_fma_f32 v127, v111, v229, -v210
    v_fma_f32 v128, v112, v229, -v210
    v_fma_f32 v129, v113, v229, -v210
    v_mov_b32 v218, v217
    v_mov_b32 v219, v217
    s_nop 1
    v_permlane16_swap_b32 v218, v219
    v_mul_f32 v244, v244, v217
    v_mul_f32 v245, v245, v219
    v_mul_f32 v34, v34, v217
    v_mul_f32 v35, v35, v217
    v_mul_f32 v36, v36, v217
    v_mul_f32 v37, v37, v217
    v_mul_f32 v38, v38, v217
    v_mul_f32 v39, v39, v217
    v_mul_f32 v40, v40, v217
    v_mul_f32 v41, v41, v217
    v_mul_f32 v42, v42, v217
    v_mul_f32 v43, v43, v217
    v_mul_f32 v44, v44, v217
    v_mul_f32 v45, v45, v217
    v_mul_f32 v46, v46, v217
    v_mul_f32 v47, v47, v217
    v_mul_f32 v48, v48, v217
    v_mul_f32 v49, v49, v217
    v_mul_f32 v50, v50, v217
    v_mul_f32 v51, v51, v217
    v_mul_f32 v52, v52, v217
    v_mul_f32 v53, v53, v217
    v_mul_f32 v54, v54, v217
    v_mul_f32 v55, v55, v217
    v_mul_f32 v56, v56, v217
    v_mul_f32 v57, v57, v217
    v_mul_f32 v58, v58, v217
    v_mul_f32 v59, v59, v217
    v_mul_f32 v60, v60, v217
    v_mul_f32 v61, v61, v217
    v_mul_f32 v62, v62, v217
    v_mul_f32 v63, v63, v217
    v_mul_f32 v64, v64, v217
    v_mul_f32 v65, v65, v217
    v_mul_f32 v66, v66, v217
    v_mul_f32 v67, v67, v217
    v_mul_f32 v68, v68, v217
    v_mul_f32 v69, v69, v217
    v_mul_f32 v70, v70, v217
    v_mul_f32 v71, v71, v217
    v_mul_f32 v72, v72, v217
    v_mul_f32 v73, v73, v217
    v_mul_f32 v74, v74, v217
    v_mul_f32 v75, v75, v217
    v_mul_f32 v76, v76, v217
    v_mul_f32 v77, v77, v217
    v_mul_f32 v78, v78, v217
    v_mul_f32 v79, v79, v217
    v_mul_f32 v80, v80, v217
    v_mul_f32 v81, v81, v217
    v_mul_f32 v82, v82, v217
    v_mul_f32 v83, v83, v217
    v_mul_f32 v84, v84, v217
    v_mul_f32 v85, v85, v217
    v_mul_f32 v86, v86, v217
    v_mul_f32 v87, v87, v217
    v_mul_f32 v88, v88, v217
    v_mul_f32 v89, v89, v217
    v_mul_f32 v90, v90, v217
    v_mul_f32 v91, v91, v217
    v_mul_f32 v92, v92, v217
    v_mul_f32 v93, v93, v217
    v_mul_f32 v94, v94, v217
    v_mul_f32 v95, v95, v217
    v_mul_f32 v96, v96, v217
    v_mul_f32 v97, v97, v217
    s_nop 1
    s_branch L_cont_e4
L_rare_e3:
    v_mov_b32 v216, v214
    s_nop 1
    v_permlane32_swap_b32 v214, v216
    v_max_f32 v214, v214, v216
    v_max_f32 v214, v214, v228
    v_sub_f32 v217, v228, v214
    v_mul_f32 v217, v229, v217
    v_exp_f32 v217, v217
    v_mov_b32 v228, v214
    v_mul_f32 v210, v229, v214
    v_add_f32 v211, s47, v214
    v_fma_f32 v114, v98, v229, -v210
    v_fma_f32 v115, v99, v229, -v210
    v_fma_f32 v116, v100, v229, -v210
    v_fma_f32 v117, v101, v229, -v210
    v_fma_f32 v118, v102, v229, -v210
    v_fma_f32 v119, v103, v229, -v210
    v_fma_f32 v120, v104, v229, -v210
    v_fma_f32 v121, v105, v229, -v210
    v_fma_f32 v122, v106, v229, -v210
    v_fma_f32 v123, v107, v229, -v210
    v_fma_f32 v124, v108, v229, -v210
    v_fma_f32 v125, v109, v229, -v210
    v_fma_f32 v126, v110, v229, -v210
    v_fma_f32 v127, v111, v229, -v210
    v_fma_f32 v128, v112, v229, -v210
    v_fma_f32 v129, v113, v229, -v210
    v_mov_b32 v218, v217
    v_mov_b32 v219, v217
    s_nop 1
    v_permlane16_swap_b32 v218, v219
    v_mul_f32 v244, v244, v217
    v_mul_f32 v245, v245, v219
    v_mul_f32 v34, v34, v217
    v_mul_f32 v35, v35, v217
    v_mul_f32 v36, v36, v217
    v_mul_f32 v37, v37, v217
    v_mul_f32 v38, v38, v217
    v_mul_f32 v39, v39, v217
    v_mul_f32 v40, v40, v217
    v_mul_f32 v41, v41, v217
    v_mul_f32 v42, v42, v217
    v_mul_f32 v43, v43, v217
    v_mul_f32 v44, v44, v217
    v_mul_f32 v45, v45, v217
    v_mul_f32 v46, v46, v217
    v_mul_f32 v47, v47, v217
    v_mul_f32 v48, v48, v217
    v_mul_f32 v49, v49, v217
    v_mul_f32 v50, v50, v217
    v_mul_f32 v51, v51, v217
    v_mul_f32 v52, v52, v217
    v_mul_f32 v53, v53, v217
    v_mul_f32 v54, v54, v217
    v_mul_f32 v55, v55, v217
    v_mul_f32 v56, v56, v217
    v_mul_f32 v57, v57, v217
    v_mul_f32 v58, v58, v217
    v_mul_f32 v59, v59, v217
    v_mul_f32 v60, v60, v217
    v_mul_f32 v61, v61, v217
    v_mul_f32 v62, v62, v217
    v_mul_f32 v63, v63, v217
    v_mul_f32 v64, v64, v217
    v_mul_f32 v65, v65, v217
    v_mul_f32 v66, v66, v217
    v_mul_f32 v67, v67, v217
    v_mul_f32 v68, v68, v217
    v_mul_f32 v69, v69, v217
    v_mul_f32 v70, v70, v217
    v_mul_f32 v71, v71, v217
    v_mul_f32 v72, v72, v217
    v_mul_f32 v73, v73, v217
    v_mul_f32 v74, v74, v217
    v_mul_f32 v75, v75, v217
    v_mul_f32 v76, v76, v217
    v_mul_f32 v77, v77, v217
    v_mul_f32 v78, v78, v217
    v_mul_f32 v79, v79, v217
    v_mul_f32 v80, v80, v217
    v_mul_f32 v81, v81, v217
    v_mul_f32 v82, v82, v217
    v_mul_f32 v83, v83, v217
    v_mul_f32 v84, v84, v217
    v_mul_f32 v85, v85, v217
    v_mul_f32 v86, v86, v217
    v_mul_f32 v87, v87, v217
    v_mul_f32 v88, v88, v217
    v_mul_f32 v89, v89, v217
    v_mul_f32 v90, v90, v217
    v_mul_f32 v91, v91, v217
    v_mul_f32 v92, v92, v217
    v_mul_f32 v93, v93, v217
    v_mul_f32 v94, v94, v217
    v_mul_f32 v95, v95, v217
    v_mul_f32 v96, v96, v217
    v_mul_f32 v97, v97, v217
    s_nop 1
    s_branch L_cont_e3
L_rare_e2:
    v_mov_b32 v216, v214
    s_nop 1
    v_permlane32_swap_b32 v214, v216
    v_max_f32 v214, v214, v216
    v_max_f32 v214, v214, v228
    v_sub_f32 v217, v228, v214
    v_mul_f32 v217, v229, v217
    v_exp_f32 v217, v217
    v_mov_b32 v228, v214
    v_mul_f32 v210, v229, v214
    v_add_f32 v211, s47, v214
    v_fma_f32 v114, v98, v229, -v210
    v_fma_f32 v115, v99, v229, -v210
    v_fma_f32 v116, v100, v229, -v210
    v_fma_f32 v117, v101, v229, -v210
    v_fma_f32 v118, v102, v229, -v210
    v_fma_f32 v119, v103, v229, -v210
    v_fma_f32 v120, v104, v229, -v210
    v_fma_f32 v121, v105, v229, -v210
    v_fma_f32 v122, v106, v229, -v210
    v_fma_f32 v123, v107, v229, -v210
    v_fma_f32 v124, v108, v229, -v210
    v_fma_f32 v125, v109, v229, -v210
    v_fma_f32 v126, v110, v229, -v210
    v_fma_f32 v127, v111, v229, -v210
    v_fma_f32 v128, v112, v229, -v210
    v_fma_f32 v129, v113, v229, -v210
    v_mov_b32 v218, v217
    v_mov_b32 v219, v217
    s_nop 1
    v_permlane16_swap_b32 v218, v219
    v_mul_f32 v244, v244, v217
    v_mul_f32 v245, v245, v219
    v_mul_f32 v34, v34, v217
    v_mul_f32 v35, v35, v217
    v_mul_f32 v36, v36, v217
    v_mul_f32 v37, v37, v217
    v_mul_f32 v38, v38, v217
    v_mul_f32 v39, v39, v217
    v_mul_f32 v40, v40, v217
    v_mul_f32 v41, v41, v217
    v_mul_f32 v42, v42, v217
    v_mul_f32 v43, v43, v217
    v_mul_f32 v44, v44, v217
    v_mul_f32 v45, v45, v217
    v_mul_f32 v46, v46, v217
    v_mul_f32 v47, v47, v217
    v_mul_f32 v48, v48, v217
    v_mul_f32 v49, v49, v217
    v_mul_f32 v50, v50, v217
    v_mul_f32 v51, v51, v217
    v_mul_f32 v52, v52, v217
    v_mul_f32 v53, v53, v217
    v_mul_f32 v54, v54, v217
    v_mul_f32 v55, v55, v217
    v_mul_f32 v56, v56, v217
    v_mul_f32 v57, v57, v217
    v_mul_f32 v58, v58, v217
    v_mul_f32 v59, v59, v217
    v_mul_f32 v60, v60, v217
    v_mul_f32 v61, v61, v217
    v_mul_f32 v62, v62, v217
    v_mul_f32 v63, v63, v217
    v_mul_f32 v64, v64, v217
    v_mul_f32 v65, v65, v217
    v_mul_f32 v66, v66, v217
    v_mul_f32 v67, v67, v217
    v_mul_f32 v68, v68, v217
    v_mul_f32 v69, v69, v217
    v_mul_f32 v70, v70, v217
    v_mul_f32 v71, v71, v217
    v_mul_f32 v72, v72, v217
    v_mul_f32 v73, v73, v217
    v_mul_f32 v74, v74, v217
    v_mul_f32 v75, v75, v217
    v_mul_f32 v76, v76, v217
    v_mul_f32 v77, v77, v217
    v_mul_f32 v78, v78, v217
    v_mul_f32 v79, v79, v217
    v_mul_f32 v80, v80, v217
    v_mul_f32 v81, v81, v217
    v_mul_f32 v82, v82, v217
    v_mul_f32 v83, v83, v217
    v_mul_f32 v84, v84, v217
    v_mul_f32 v85, v85, v217
    v_mul_f32 v86, v86, v217
    v_mul_f32 v87, v87, v217
    v_mul_f32 v88, v88, v217
    v_mul_f32 v89, v89, v217
    v_mul_f32 v90, v90, v217
    v_mul_f32 v91, v91, v217
    v_mul_f32 v92, v92, v217
    v_mul_f32 v93, v93, v217
    v_mul_f32 v94, v94, v217
    v_mul_f32 v95, v95, v217
    v_mul_f32 v96, v96, v217
    v_mul_f32 v97, v97, v217
    s_nop 1
    s_branch L_cont_e2
L_rare_e1:
    v_mov_b32 v216, v214
    s_nop 1
    v_permlane32_swap_b32 v214, v216
    v_max_f32 v214, v214, v216
    v_max_f32 v214, v214, v228
    v_sub_f32 v217, v228, v214
    v_mul_f32 v217, v229, v217
    v_exp_f32 v217, v217
    v_mov_b32 v228, v214
    v_mul_f32 v210, v229, v214
    v_add_f32 v211, s47, v214
    v_fma_f32 v114, v98, v229, -v210
    v_fma_f32 v115, v99, v229, -v210
    v_fma_f32 v116, v100, v229, -v210
    v_fma_f32 v117, v101, v229, -v210
    v_fma_f32 v118, v102, v229, -v210
    v_fma_f32 v119, v103, v229, -v210
    v_fma_f32 v120, v104, v229, -v210
    v_fma_f32 v121, v105, v229, -v210
    v_fma_f32 v122, v106, v229, -v210
    v_fma_f32 v123, v107, v229, -v210
    v_fma_f32 v124, v108, v229, -v210
    v_fma_f32 v125, v109, v229, -v210
    v_fma_f32 v126, v110, v229, -v210
    v_fma_f32 v127, v111, v229, -v210
    v_fma_f32 v128, v112, v229, -v210
    v_fma_f32 v129, v113, v229, -v210
    v_mov_b32 v218, v217
    v_mov_b32 v219, v217
    s_nop 1
    v_permlane16_swap_b32 v218, v219
    v_mul_f32 v244, v244, v217
    v_mul_f32 v245, v245, v219
    v_mul_f32 v34, v34, v217
    v_mul_f32 v35, v35, v217
    v_mul_f32 v36, v36, v217
    v_mul_f32 v37, v37, v217
    v_mul_f32 v38, v38, v217
    v_mul_f32 v39, v39, v217
    v_mul_f32 v40, v40, v217
    v_mul_f32 v41, v41, v217
    v_mul_f32 v42, v42, v217
    v_mul_f32 v43, v43, v217
    v_mul_f32 v44, v44, v217
    v_mul_f32 v45, v45, v217
    v_mul_f32 v46, v46, v217
    v_mul_f32 v47, v47, v217
    v_mul_f32 v48, v48, v217
    v_mul_f32 v49, v49, v217
    v_mul_f32 v50, v50, v217
    v_mul_f32 v51, v51, v217
    v_mul_f32 v52, v52, v217
    v_mul_f32 v53, v53, v217
    v_mul_f32 v54, v54, v217
    v_mul_f32 v55, v55, v217
    v_mul_f32 v56, v56, v217
    v_mul_f32 v57, v57, v217
    v_mul_f32 v58, v58, v217
    v_mul_f32 v59, v59, v217
    v_mul_f32 v60, v60, v217
    v_mul_f32 v61, v61, v217
    v_mul_f32 v62, v62, v217
    v_mul_f32 v63, v63, v217
    v_mul_f32 v64, v64, v217
    v_mul_f32 v65, v65, v217
    v_mul_f32 v66, v66, v217
    v_mul_f32 v67, v67, v217
    v_mul_f32 v68, v68, v217
    v_mul_f32 v69, v69, v217
    v_mul_f32 v70, v70, v217
    v_mul_f32 v71, v71, v217
    v_mul_f32 v72, v72, v217
    v_mul_f32 v73, v73, v217
    v_mul_f32 v74, v74, v217
    v_mul_f32 v75, v75, v217
    v_mul_f32 v76, v76, v217
    v_mul_f32 v77, v77, v217
    v_mul_f32 v78, v78, v217
    v_mul_f32 v79, v79, v217
    v_mul_f32 v80, v80, v217
    v_mul_f32 v81, v81, v217
    v_mul_f32 v82, v82, v217
    v_mul_f32 v83, v83, v217
    v_mul_f32 v84, v84, v217
    v_mul_f32 v85, v85, v217
    v_mul_f32 v86, v86, v217
    v_mul_f32 v87, v87, v217
    v_mul_f32 v88, v88, v217
    v_mul_f32 v89, v89, v217
    v_mul_f32 v90, v90, v217
    v_mul_f32 v91, v91, v217
    v_mul_f32 v92, v92, v217
    v_mul_f32 v93, v93, v217
    v_mul_f32 v94, v94, v217
    v_mul_f32 v95, v95, v217
    v_mul_f32 v96, v96, v217
    v_mul_f32 v97, v97, v217
    s_nop 1
    s_branch L_cont_e1
L_end:
    s_endpgm
.p2align 6
.type L_table,@object
L_table:
    .long 0xfbe000, 0x1b400, 0x377800, 0x7ed00, 0x78000, 0x10, 0x6300, 0x1
    .long 0xfbe400, 0x1b400, 0x377900, 0x7ed00, 0x78000, 0x10, 0x6300, 0x1
    .long 0xfbe800, 0x1b400, 0x377a00, 0x7ed00, 0x78000, 0x10, 0x6300, 0x1
    .long 0xfbec00, 0x1b400, 0x377b00, 0x7ed00, 0x78000, 0x10, 0x6300, 0x1
    .long 0x2c7000, 0x16400, 0x61c00, 0x55900, 0x50000, 0xb, 0x4200, 0x0
    .long 0x2c7400, 0x16400, 0x61d00, 0x55900, 0x50000, 0xb, 0x4200, 0x0
    .long 0x2c7800, 0x16400, 0x61e00, 0x55900, 0x50000, 0xb, 0x4200, 0x0
    .long 0x2c7c00, 0x16400, 0x61f00, 0x55900, 0x50000, 0xb, 0x4200, 0x0
    .long 0xf9e000, 0x1f400, 0x377800, 0x7ed00, 0x70000, 0xf, 0x4200, 0x1
    .long 0xf9e400, 0x1f400, 0x377900, 0x7ed00, 0x70000, 0xf, 0x4200, 0x1
    .long 0xf9e800, 0x1f400, 0x377a00, 0x7ed00, 0x70000, 0xf, 0x4200, 0x1
    .long 0xf9ec00, 0x1f400, 0x377b00, 0x7ed00, 0x70000, 0xf, 0x4200, 0x1
    .long 0x5b9400, 0x14400, 0x11e500, 0x55100, 0x50000, 0xb, 0x4200, 0x0
    .long 0x5b9800, 0x14400, 0x11e600, 0x55100, 0x50000, 0xb, 0x4200, 0x0
    .long 0x5b9c00, 0x14400, 0x11e700, 0x55100, 0x50000, 0xb, 0x4200, 0x0
    .long 0x5b9000, 0x14400, 0x11e400, 0x55100, 0x50000, 0xb, 0x4200, 0x0
    .long 0xa95400, 0x17400, 0x235500, 0x75d00, 0x70000, 0xf, 0x4200, 0x1
    .long 0xa95800, 0x17400, 0x235600, 0x75d00, 0x70000, 0xf, 0x4200, 0x1
    .long 0xa95c00, 0x17400, 0x235700, 0x75d00, 0x70000, 0xf, 0x4200, 0x1
    .long 0xa95000, 0x17400, 0x235400, 0x75d00, 0x70000, 0xf, 0x4200, 0x1
    .long 0x8c0800, 0x14400, 0x1e0200, 0x55100, 0x50000, 0xb, 0x4200, 0x0
    .long 0x8c0c00, 0x14400, 0x1e0300, 0x55100, 0x50000, 0xb, 0x4200, 0x0
    .long 0x8c0000, 0x14400, 0x1e0000, 0x55100, 0x50000, 0xb, 0x4200, 0x0
    .long 0x8c0400, 0x14400, 0x1e0100, 0x55100, 0x50000, 0xb, 0x4200, 0x0
    .long 0xf7e000, 0x1f400, 0x377800, 0x7ed00, 0x68000, 0xe, 0x2100, 0x0
    .long 0xf7e400, 0x1f400, 0x377900, 0x7ed00, 0x68000, 0xe, 0x2100, 0x0
    .long 0xf7e800, 0x1f400, 0x377a00, 0x7ed00, 0x68000, 0xe, 0x2100, 0x0
    .long 0xf7ec00, 0x1f400, 0x377b00, 0x7ed00, 0x68000, 0xe, 0x2100, 0x0
    .long 0x2a7000, 0x1f400, 0x61c00, 0x55900, 0x48000, 0xa, 0x2100, 0x0
    .long 0x2a7400, 0x1f400, 0x61d00, 0x55900, 0x48000, 0xa, 0x2100, 0x0
    .long 0x2a7800, 0x1f400, 0x61e00, 0x55900, 0x48000, 0xa, 0x2100, 0x0
    .long 0x2a7c00, 0x1f400, 0x61f00, 0x55900, 0x48000, 0xa, 0x2100, 0x0
    .long 0xa75400, 0x1f400, 0x235500, 0x75d00, 0x68000, 0xe, 0x2100, 0x0
    .long 0xa75800, 0x1f400, 0x235600, 0x75d00, 0x68000, 0xe, 0x2100, 0x0
    .long 0xa75c00, 0x1f400, 0x235700, 0x75d00, 0x68000, 0xe, 0x2100, 0x0
    .long 0xa75000, 0x1f400, 0x235400, 0x75d00, 0x68000, 0xe, 0x2100, 0x0
    .long 0x599400, 0x1f400, 0x11e500, 0x55100, 0x48000, 0xa, 0x2100, 0x0
    .long 0x599800, 0x1f400, 0x11e600, 0x55100, 0x48000, 0xa, 0x2100, 0x0
    .long 0x599c00, 0x1f400, 0x11e700, 0x55100, 0x48000, 0xa, 0x2100, 0x0
    .long 0x599000, 0x1f400, 0x11e400, 0x55100, 0x48000, 0xa, 0x2100, 0x0
    .long 0xf5e000, 0x1f400, 0x377800, 0x7ed00, 0x60000, 0xd, 0x0, 0x0
    .long 0xf5e400, 0x1f400, 0x377900, 0x7ed00, 0x60000, 0xd, 0x0, 0x0
    .long 0xf5e800, 0x1f400, 0x377a00, 0x7ed00, 0x60000, 0xd, 0x0, 0x0
    .long 0xf5ec00, 0x1f400, 0x377b00, 0x7ed00, 0x60000, 0xd, 0x0, 0x0
    .long 0x8a0800, 0x1f400, 0x1e0200, 0x55100, 0x48000, 0xa, 0x2100, 0x0
    .long 0x8a0c00, 0x1f400, 0x1e0300, 0x55100, 0x48000, 0xa, 0x2100, 0x0
    .long 0x8a0000, 0x1f400, 0x1e0000, 0x55100, 0x48000, 0xa, 0x2100, 0x0
    .long 0x8a0400, 0x1f400, 0x1e0100, 0x55100, 0x48000, 0xa, 0x2100, 0x0
    .long 0xa55400, 0x1f400, 0x235500, 0x75d00, 0x60000, 0xd, 0x0, 0x0
    .long 0xa55800, 0x1f400, 0x235600, 0x75d00, 0x60000, 0xd, 0x0, 0x0
    .long 0xa55c00, 0x1f400, 0x235700, 0x75d00, 0x60000, 0xd, 0x0, 0x0
    .long 0xa55000, 0x1f400, 0x235400, 0x75d00, 0x60000, 0xd, 0x0, 0x0
    .long 0xcc2c00, 0x9400, 0x2e8b00, 0x4a500, 0x48000, 0xa, 0x2100, 0x0
    .long 0xcc2000, 0x9400, 0x2e8800, 0x4a500, 0x48000, 0xa, 0x2100, 0x0
    .long 0xcc2400, 0x9400, 0x2e8900, 0x4a500, 0x48000, 0xa, 0x2100, 0x0
    .long 0xcc2800, 0x9400, 0x2e8a00, 0x4a500, 0x48000, 0xa, 0x2100, 0x0
    .long 0x45e800, 0x1a400, 0xb7a00, 0x66900, 0x60000, 0xd, 0x0, 0x0
    .long 0x45ec00, 0x1a400, 0xb7b00, 0x66900, 0x60000, 0xd, 0x0, 0x0
    .long 0x45e000, 0x1a400, 0xb7800, 0x66900, 0x60000, 0xd, 0x0, 0x0
    .long 0x45e400, 0x1a400, 0xb7900, 0x66900, 0x60000, 0xd, 0x0, 0x0
    .long 0x287000, 0x1f400, 0x61c00, 0x55900, 0x40000, 0x9, 0x0, 0x0
    .long 0x287400, 0x1f400, 0x61d00, 0x55900, 0x40000, 0x9, 0x0, 0x0
    .long 0x287800, 0x1f400, 0x61e00, 0x55900, 0x40000, 0x9, 0x0, 0x0
    .long 0x287c00, 0x1f400, 0x61f00, 0x55900, 0x40000, 0x9, 0x0, 0x0
    .long 0xf3e000, 0x1f400, 0x377800, 0x7ed00, 0x58000, 0xc, 0x6300, 0x0
    .long 0xf3e400, 0x1f400, 0x377900, 0x7ed00, 0x58000, 0xc, 0x6300, 0x0
    .long 0xf3e800, 0x1f400, 0x377a00, 0x7ed00, 0x58000, 0xc, 0x6300, 0x0
    .long 0xf3ec00, 0x1f400, 0x377b00, 0x7ed00, 0x58000, 0xc, 0x6300, 0x0
    .long 0x579400, 0x1f400, 0x11e500, 0x55100, 0x40000, 0x9, 0x0, 0x0
    .long 0x579800, 0x1f400, 0x11e600, 0x55100, 0x40000, 0x9, 0x0, 0x0
    .long 0x579c00, 0x1f400, 0x11e700, 0x55100, 0x40000, 0x9, 0x0, 0x0
    .long 0x579000, 0x1f400, 0x11e400, 0x55100, 0x40000, 0x9, 0x0, 0x0
    .long 0xa35400, 0x1f400, 0x235500, 0x75d00, 0x58000, 0xc, 0x6300, 0x0
    .long 0xa35800, 0x1f400, 0x235600, 0x75d00, 0x58000, 0xc, 0x6300, 0x0
    .long 0xa35c00, 0x1f400, 0x235700, 0x75d00, 0x58000, 0xc, 0x6300, 0x0
    .long 0xa35000, 0x1f400, 0x235400, 0x75d00, 0x58000, 0xc, 0x6300, 0x0
    .long 0x880800, 0x1f400, 0x1e0200, 0x55100, 0x40000, 0x9, 0x0, 0x0
    .long 0x880c00, 0x1f400, 0x1e0300, 0x55100, 0x40000, 0x9, 0x0, 0x0
    .long 0x880000, 0x1f400, 0x1e0000, 0x55100, 0x40000, 0x9, 0x0, 0x0
    .long 0x880400, 0x1f400, 0x1e0100, 0x55100, 0x40000, 0x9, 0x0, 0x0
    .long 0x43e800, 0x1f400, 0xb7a00, 0x66900, 0x58000, 0xc, 0x6300, 0x0
    .long 0x43ec00, 0x1f400, 0xb7b00, 0x66900, 0x58000, 0xc, 0x6300, 0x0
    .long 0x43e000, 0x1f400, 0xb7800, 0x66900, 0x58000, 0xc, 0x6300, 0x0
    .long 0x43e400, 0x1f400, 0xb7900, 0x66900, 0x58000, 0xc, 0x6300, 0x0
    .long 0xca2c00, 0x1f400, 0x2e8b00, 0x4a500, 0x40000, 0x9, 0x0, 0x0
    .long 0xca2000, 0x1f400, 0x2e8800, 0x4a500, 0x40000, 0x9, 0x0, 0x0
    .long 0xca2400, 0x1f400, 0x2e8900, 0x4a500, 0x40000, 0x9, 0x0, 0x0
    .long 0xca2800, 0x1f400, 0x2e8a00, 0x4a500, 0x40000, 0x9, 0x0, 0x0
    .long 0xf1e000, 0x1f400, 0x377800, 0x7ed00, 0x50000, 0xb, 0x4200, 0x0
    .long 0xf1e400, 0x1f400, 0x377900, 0x7ed00, 0x50000, 0xb, 0x4200, 0x0
    .long 0xf1e800, 0x1f400, 0x377a00, 0x7ed00, 0x50000, 0xb, 0x4200, 0x0
    .long 0xf1ec00, 0x1f400, 0x377b00, 0x7ed00, 0x50000, 0xb, 0x4200, 0x0
    .long 0xdcc000, 0x11400, 0x333000, 0x44500, 0x40000, 0x9, 0x0, 0x0
    .long 0xdcc400, 0x11400, 0x333100, 0x44500, 0x40000, 0x9, 0x0, 0x0
    .long 0xdcc800, 0x11400, 0x333200, 0x44500, 0x40000, 0x9, 0x0, 0x0
    .long 0xdccc00, 0x11400, 0x333300, 0x44500, 0x40000, 0x9, 0x0, 0x0
    .long 0xa15400, 0x1f400, 0x235500, 0x75d00, 0x50000, 0xb, 0x4200, 0x0
    .long 0xa15800, 0x1f400, 0x235600, 0x75d00, 0x50000, 0xb, 0x4200, 0x0
    .long 0xa15c00, 0x1f400, 0x235700, 0x75d00, 0x50000, 0xb, 0x4200, 0x0
    .long 0xa15000, 0x1f400, 0x235400, 0x75d00, 0x50000, 0xb, 0x4200, 0x0
    .long 0x267000, 0x1f400, 0x61c00, 0x55900, 0x38000, 0x8, 0x6300, 0x0
    .long 0x267400, 0x1f400, 0x61d00, 0x55900, 0x38000, 0x8, 0x6300, 0x0
    .long 0x267800, 0x1f400, 0x61e00, 0x55900, 0x38000, 0x8, 0x6300, 0x0
    .long 0x267c00, 0x1f400, 0x61f00, 0x55900, 0x38000, 0x8, 0x6300, 0x0
    .long 0x41e800, 0x1f400, 0xb7a00, 0x66900, 0x50000, 0xb, 0x4200, 0x0
    .long 0x41ec00, 0x1f400, 0xb7b00, 0x66900, 0x50000, 0xb, 0x4200, 0x0
    .long 0x41e000, 0x1f400, 0xb7800, 0x66900, 0x50000, 0xb, 0x4200, 0x0
    .long 0x41e400, 0x1f400, 0xb7900, 0x66900, 0x50000, 0xb, 0x4200, 0x0
    .long 0x559400, 0x1f400, 0x11e500, 0x55100, 0x38000, 0x8, 0x6300, 0x0
    .long 0x559800, 0x1f400, 0x11e600, 0x55100, 0x38000, 0x8, 0x6300, 0x0
    .long 0x559c00, 0x1f400, 0x11e700, 0x55100, 0x38000, 0x8, 0x6300, 0x0
    .long 0x559000, 0x1f400, 0x11e400, 0x55100, 0x38000, 0x8, 0x6300, 0x0
    .long 0xefe000, 0x1f400, 0x377800, 0x7ed00, 0x48000, 0xa, 0x2100, 0x0
    .long 0xefe400, 0x1f400, 0x377900, 0x7ed00, 0x48000, 0xa, 0x2100, 0x0
    .long 0xefe800, 0x1f400, 0x377a00, 0x7ed00, 0x48000, 0xa, 0x2100, 0x0
    .long 0xefec00, 0x1f400, 0x377b00, 0x7ed00, 0x48000, 0xa, 0x2100, 0x0
    .long 0x860800, 0x1f400, 0x1e0200, 0x55100, 0x38000, 0x8, 0x6300, 0x0
    .long 0x860c00, 0x1f400, 0x1e0300, 0x55100, 0x38000, 0x8, 0x6300, 0x0
    .long 0x860000, 0x1f400, 0x1e0000, 0x55100, 0x38000, 0x8, 0x6300, 0x0
    .long 0x860400, 0x1f400, 0x1e0100, 0x55100, 0x38000, 0x8, 0x6300, 0x0
    .long 0x9f5400, 0x1f400, 0x235500, 0x75d00, 0x48000, 0xa, 0x2100, 0x0
    .long 0x9f5800, 0x1f400, 0x235600, 0x75d00, 0x48000, 0xa, 0x2100, 0x0
    .long 0x9f5c00, 0x1f400, 0x235700, 0x75d00, 0x48000, 0xa, 0x2100, 0x0
    .long 0x9f5000, 0x1f400, 0x235400, 0x75d00, 0x48000, 0xa, 0x2100, 0x0
    .long 0xc82c00, 0x1f400, 0x2e8b00, 0x4a500, 0x38000, 0x8, 0x6300, 0x0
    .long 0xc82000, 0x1f400, 0x2e8800, 0x4a500, 0x38000, 0x8, 0x6300, 0x0
    .long 0xc82400, 0x1f400, 0x2e8900, 0x4a500, 0x38000, 0x8, 0x6300, 0x0
    .long 0xc82800, 0x1f400, 0x2e8a00, 0x4a500, 0x38000, 0x8, 0x6300, 0x0
    .long 0x3fe800, 0x1f400, 0xb7a00, 0x66900, 0x48000, 0xa, 0x2100, 0x0
    .long 0x3fec00, 0x1f400, 0xb7b00, 0x66900, 0x48000, 0xa, 0x2100, 0x0
    .long 0x3fe000, 0x1f400, 0xb7800, 0x66900, 0x48000, 0xa, 0x2100, 0x0
    .long 0x3fe400, 0x1f400, 0xb7900, 0x66900, 0x48000, 0xa, 0x2100, 0x0
    .long 0xdac000, 0x1f400, 0x333000, 0x44500, 0x38000, 0x8, 0x6300, 0x0
    .long 0xdac400, 0x1f400, 0x333100, 0x44500, 0x38000, 0x8, 0x6300, 0x0
    .long 0xdac800, 0x1f400, 0x333200, 0x44500, 0x38000, 0x8, 0x6300, 0x0
    .long 0xdacc00, 0x1f400, 0x333300, 0x44500, 0x38000, 0x8, 0x6300, 0x0
    .long 0xede000, 0x1f400, 0x377800, 0x7ed00, 0x40000, 0x9, 0x0, 0x0
    .long 0xede400, 0x1f400, 0x377900, 0x7ed00, 0x40000, 0x9, 0x0, 0x0
    .long 0xede800, 0x1f400, 0x377a00, 0x7ed00, 0x40000, 0x9, 0x0, 0x0
    .long 0xedec00, 0x1f400, 0x377b00, 0x7ed00, 0x40000, 0x9, 0x0, 0x0
    .long 0x247000, 0x1f400, 0x61c00, 0x55900, 0x30000, 0x7, 0x4200, 0x0
    .long 0x247400, 0x1f400, 0x61d00, 0x55900, 0x30000, 0x7, 0x4200, 0x0
    .long 0x247800, 0x1f400, 0x61e00, 0x55900, 0x30000, 0x7, 0x4200, 0x0
    .long 0x247c00, 0x1f400, 0x61f00, 0x55900, 0x30000, 0x7, 0x4200, 0x0
    .long 0x9d5400, 0x1f400, 0x235500, 0x75d00, 0x40000, 0x9, 0x0, 0x0
    .long 0x9d5800, 0x1f400, 0x235600, 0x75d00, 0x40000, 0x9, 0x0, 0x0
    .long 0x9d5c00, 0x1f400, 0x235700, 0x75d00, 0x40000, 0x9, 0x0, 0x0
    .long 0x9d5000, 0x1f400, 0x235400, 0x75d00, 0x40000, 0x9, 0x0, 0x0
    .long 0x539400, 0x1f400, 0x11e500, 0x55100, 0x30000, 0x7, 0x4200, 0x0
    .long 0x539800, 0x1f400, 0x11e600, 0x55100, 0x30000, 0x7, 0x4200, 0x0
    .long 0x539c00, 0x1f400, 0x11e700, 0x55100, 0x30000, 0x7, 0x4200, 0x0
    .long 0x539000, 0x1f400, 0x11e400, 0x55100, 0x30000, 0x7, 0x4200, 0x0
    .long 0x3de800, 0x1f400, 0xb7a00, 0x66900, 0x40000, 0x9, 0x0, 0x0
    .long 0x3dec00, 0x1f400, 0xb7b00, 0x66900, 0x40000, 0x9, 0x0, 0x0
    .long 0x3de000, 0x1f400, 0xb7800, 0x66900, 0x40000, 0x9, 0x0, 0x0
    .long 0x3de400, 0x1f400, 0xb7900, 0x66900, 0x40000, 0x9, 0x0, 0x0
    .long 0x840800, 0x1f400, 0x1e0200, 0x55100, 0x30000, 0x7, 0x4200, 0x0
    .long 0x840c00, 0x1f400, 0x1e0300, 0x55100, 0x30000, 0x7, 0x4200, 0x0
    .long 0x840000, 0x1f400, 0x1e0000, 0x55100, 0x30000, 0x7, 0x4200, 0x0
    .long 0x840400, 0x1f400, 0x1e0100, 0x55100, 0x30000, 0x7, 0x4200, 0x0
    .long 0x100c00, 0xa400, 0x300, 0x42900, 0x40000, 0x9, 0x0, 0x0
    .long 0x100000, 0xa400, 0x0, 0x42900, 0x40000, 0x9, 0x0, 0x0
    .long 0x100400, 0xa400, 0x100, 0x42900, 0x40000, 0x9, 0x0, 0x0
    .long 0x100800, 0xa400, 0x200, 0x42900, 0x40000, 0x9, 0x0, 0x0
    .long 0xc62c00, 0x1f400, 0x2e8b00, 0x4a500, 0x30000, 0x7, 0x4200, 0x0
    .long 0xc62000, 0x1f400, 0x2e8800, 0x4a500, 0x30000, 0x7, 0x4200, 0x0
    .long 0xc62400, 0x1f400, 0x2e8900, 0x4a500, 0x30000, 0x7, 0x4200, 0x0
    .long 0xc62800, 0x1f400, 0x2e8a00, 0x4a500, 0x30000, 0x7, 0x4200, 0x0
    .long 0xebe000, 0x1f400, 0x377800, 0x7ed00, 0x38000, 0x8, 0x6300, 0x0
    .long 0xebe400, 0x1f400, 0x377900, 0x7ed00, 0x38000, 0x8, 0x6300, 0x0
    .long 0xebe800, 0x1f400, 0x377a00, 0x7ed00, 0x38000, 0x8, 0x6300, 0x0
    .long 0xebec00, 0x1f400, 0x377b00, 0x7ed00, 0x38000, 0x8, 0x6300, 0x0
    .long 0xd8c000, 0x1f400, 0x333000, 0x44500, 0x30000, 0x7, 0x4200, 0x0
    .long 0xd8c400, 0x1f400, 0x333100, 0x44500, 0x30000, 0x7, 0x4200, 0x0
    .long 0xd8c800, 0x1f400, 0x333200, 0x44500, 0x30000, 0x7, 0x4200, 0x0
    .long 0xd8cc00, 0x1f400, 0x333300, 0x44500, 0x30000, 0x7, 0x4200, 0x0
    .long 0x9b5400, 0x1f400, 0x235500, 0x75d00, 0x38000, 0x8, 0x6300, 0x0
    .long 0x9b5800, 0x1f400, 0x235600, 0x75d00, 0x38000, 0x8, 0x6300, 0x0
    .long 0x9b5c00, 0x1f400, 0x235700, 0x75d00, 0x38000, 0x8, 0x6300, 0x0
    .long 0x9b5000, 0x1f400, 0x235400, 0x75d00, 0x38000, 0x8, 0x6300, 0x0
    .long 0x6f2400, 0xe400, 0x18c900, 0x33900, 0x30000, 0x7, 0x4200, 0x0
    .long 0x6f2800, 0xe400, 0x18ca00, 0x33900, 0x30000, 0x7, 0x4200, 0x0
    .long 0x6f2c00, 0xe400, 0x18cb00, 0x33900, 0x30000, 0x7, 0x4200, 0x0
    .long 0x6f2000, 0xe400, 0x18c800, 0x33900, 0x30000, 0x7, 0x4200, 0x0
    .long 0x3be800, 0x1f400, 0xb7a00, 0x66900, 0x38000, 0x8, 0x6300, 0x0
    .long 0x3bec00, 0x1f400, 0xb7b00, 0x66900, 0x38000, 0x8, 0x6300, 0x0
    .long 0x3be000, 0x1f400, 0xb7800, 0x66900, 0x38000, 0x8, 0x6300, 0x0
    .long 0x3be400, 0x1f400, 0xb7900, 0x66900, 0x38000, 0x8, 0x6300, 0x0
    .long 0x227000, 0x1f400, 0x61c00, 0x55900, 0x28000, 0x6, 0x2100, 0x0
    .long 0x227400, 0x1f400, 0x61d00, 0x55900, 0x28000, 0x6, 0x2100, 0x0
    .long 0x227800, 0x1f400, 0x61e00, 0x55900, 0x28000, 0x6, 0x2100, 0x0
    .long 0x227c00, 0x1f400, 0x61f00, 0x55900, 0x28000, 0x6, 0x2100, 0x0
    .long 0xe0c00, 0x1f400, 0x300, 0x42900, 0x38000, 0x8, 0x6300, 0x0
    .long 0xe0000, 0x1f400, 0x0, 0x42900, 0x38000, 0x8, 0x6300, 0x0
    .long 0xe0400, 0x1f400, 0x100, 0x42900, 0x38000, 0x8, 0x6300, 0x0
    .long 0xe0800, 0x1f400, 0x200, 0x42900, 0x38000, 0x8, 0x6300, 0x0
    .long 0x519400, 0x1f400, 0x11e500, 0x55100, 0x28000, 0x6, 0x2100, 0x0
    .long 0x519800, 0x1f400, 0x11e600, 0x55100, 0x28000, 0x6, 0x2100, 0x0
    .long 0x519c00, 0x1f400, 0x11e700, 0x55100, 0x28000, 0x6, 0x2100, 0x0
    .long 0x519000, 0x1f400, 0x11e400, 0x55100, 0x28000, 0x6, 0x2100, 0x0
    .long 0xe9e000, 0x1f400, 0x377800, 0x7ed00, 0x30000, 0x7, 0x4200, 0x0
    .long 0xe9e400, 0x1f400, 0x377900, 0x7ed00, 0x30000, 0x7, 0x4200, 0x0
    .long 0xe9e800, 0x1f400, 0x377a00, 0x7ed00, 0x30000, 0x7, 0x4200, 0x0
    .long 0xe9ec00, 0x1f400, 0x377b00, 0x7ed00, 0x30000, 0x7, 0x4200, 0x0
    .long 0x820800, 0x1f400, 0x1e0200, 0x55100, 0x28000, 0x6, 0x2100, 0x0
    .long 0x820c00, 0x1f400, 0x1e0300, 0x55100, 0x28000, 0x6, 0x2100, 0x0
    .long 0x820000, 0x1f400, 0x1e0000, 0x55100, 0x28000, 0x6, 0x2100, 0x0
    .long 0x820400, 0x1f400, 0x1e0100, 0x55100, 0x28000, 0x6, 0x2100, 0x0
    .long 0x995400, 0x1f400, 0x235500, 0x75d00, 0x30000, 0x7, 0x4200, 0x0
    .long 0x995800, 0x1f400, 0x235600, 0x75d00, 0x30000, 0x7, 0x4200, 0x0
    .long 0x995c00, 0x1f400, 0x235700, 0x75d00, 0x30000, 0x7, 0x4200, 0x0
    .long 0x995000, 0x1f400, 0x235400, 0x75d00, 0x30000, 0x7, 0x4200, 0x0
    .long 0xc42c00, 0x1f400, 0x2e8b00, 0x4a500, 0x28000, 0x6, 0x2100, 0x0
    .long 0xc42000, 0x1f400, 0x2e8800, 0x4a500, 0x28000, 0x6, 0x2100, 0x0
    .long 0xc42400, 0x1f400, 0x2e8900, 0x4a500, 0x28000, 0x6, 0x2100, 0x0
    .long 0xc42800, 0x1f400, 0x2e8a00, 0x4a500, 0x28000, 0x6, 0x2100, 0x0
    .long 0x39e800, 0x1f400, 0xb7a00, 0x66900, 0x30000, 0x7, 0x4200, 0x0
    .long 0x39ec00, 0x1f400, 0xb7b00, 0x66900, 0x30000, 0x7, 0x4200, 0x0
    .long 0x39e000, 0x1f400, 0xb7800, 0x66900, 0x30000, 0x7, 0x4200, 0x0
    .long 0x39e400, 0x1f400, 0xb7900, 0x66900, 0x30000, 0x7, 0x4200, 0x0
    .long 0xd6c000, 0x1f400, 0x333000, 0x44500, 0x28000, 0x6, 0x2100, 0x0
    .long 0xd6c400, 0x1f400, 0x333100, 0x44500, 0x28000, 0x6, 0x2100, 0x0
    .long 0xd6c800, 0x1f400, 0x333200, 0x44500, 0x28000, 0x6, 0x2100, 0x0
    .long 0xd6cc00, 0x1f400, 0x333300, 0x44500, 0x28000, 0x6, 0x2100, 0x0
    .long 0xc0c00, 0x1f400, 0x300, 0x42900, 0x30000, 0x7, 0x4200, 0x0
    .long 0xc0000, 0x1f400, 0x0, 0x42900, 0x30000, 0x7, 0x4200, 0x0
    .long 0xc0400, 0x1f400, 0x100, 0x42900, 0x30000, 0x7, 0x4200, 0x0
    .long 0xc0800, 0x1f400, 0x200, 0x42900, 0x30000, 0x7, 0x4200, 0x0
    .long 0x6d2400, 0x1f400, 0x18c900, 0x33900, 0x28000, 0x6, 0x2100, 0x0
    .long 0x6d2800, 0x1f400, 0x18ca00, 0x33900, 0x28000, 0x6, 0x2100, 0x0
    .long 0x6d2c00, 0x1f400, 0x18cb00, 0x33900, 0x28000, 0x6, 0x2100, 0x0
    .long 0x6d2000, 0x1f400, 0x18c800, 0x33900, 0x28000, 0x6, 0x2100, 0x0
    .long 0xe7e000, 0x1f400, 0x377800, 0x7ed00, 0x28000, 0x6, 0x2100, 0x0
    .long 0xe7e400, 0x1f400, 0x377900, 0x7ed00, 0x28000, 0x6, 0x2100, 0x0
    .long 0xe7e800, 0x1f400, 0x377a00, 0x7ed00, 0x28000, 0x6, 0x2100, 0x0
    .long 0xe7ec00, 0x1f400, 0x377b00, 0x7ed00, 0x28000, 0x6, 0x2100, 0x0
    .long 0x107a800, 0x1e400, 0x3f6a00, 0x2f900, 0x28000, 0x6, 0x2100, 0x0
    .long 0x107ac00, 0x1e400, 0x3f6b00, 0x2f900, 0x28000, 0x6, 0x2100, 0x0
    .long 0x107a000, 0x1e400, 0x3f6800, 0x2f900, 0x28000, 0x6, 0x2100, 0x0
    .long 0x107a400, 0x1e400, 0x3f6900, 0x2f900, 0x28000, 0x6, 0x2100, 0x0
    .long 0x975400, 0x1f400, 0x235500, 0x75d00, 0x28000, 0x6, 0x2100, 0x0
    .long 0x975800, 0x1f400, 0x235600, 0x75d00, 0x28000, 0x6, 0x2100, 0x0
    .long 0x975c00, 0x1f400, 0x235700, 0x75d00, 0x28000, 0x6, 0x2100, 0x0
    .long 0x975000, 0x1f400, 0x235400, 0x75d00, 0x28000, 0x6, 0x2100, 0x0
    .long 0x1a7000, 0x1f400, 0x61c00, 0x55900, 0x8000, 0x2, 0x2100, 0x4
    .long 0x1a7400, 0x1f400, 0x61d00, 0x55900, 0x8000, 0x2, 0x2100, 0x4
    .long 0x1a7800, 0x1f400, 0x61e00, 0x55900, 0x8000, 0x2, 0x2100, 0x4
    .long 0x1a7c00, 0x1f400, 0x61f00, 0x55900, 0x8000, 0x2, 0x2100, 0x4
    .long 0x37e800, 0x1f400, 0xb7a00, 0x66900, 0x28000, 0x6, 0x2100, 0x0
    .long 0x37ec00, 0x1f400, 0xb7b00, 0x66900, 0x28000, 0x6, 0x2100, 0x0
    .long 0x37e000, 0x1f400, 0xb7800, 0x66900, 0x28000, 0x6, 0x2100, 0x0
    .long 0x37e400, 0x1f400, 0xb7900, 0x66900, 0x28000, 0x6, 0x2100, 0x0
    .long 0x499400, 0x1f400, 0x11e500, 0x55100, 0x8000, 0x2, 0x2100, 0x4
    .long 0x499800, 0x1f400, 0x11e600, 0x55100, 0x8000, 0x2, 0x2100, 0x4
    .long 0x499c00, 0x1f400, 0x11e700, 0x55100, 0x8000, 0x2, 0x2100, 0x4
    .long 0x499000, 0x1f400, 0x11e400, 0x55100, 0x8000, 0x2, 0x2100, 0x4
    .long 0x5ce400, 0x1f400, 0x173900, 0x18d00, 0x0, 0x1, 0x0, 0x2
    .long 0x5ce800, 0x1f400, 0x173a00, 0x18d00, 0x0, 0x1, 0x0, 0x2
    .long 0x5cec00, 0x1f400, 0x173b00, 0x18d00, 0x0, 0x1, 0x0, 0x2
    .long 0x5ce000, 0x1f400, 0x173800, 0x18d00, 0x0, 0x1, 0x0, 0x2
    .long 0xb6cc00, 0x1f400, 0x2cb300, 0x1d500, 0x10000, 0x3, 0x4200, 0x3
    .long 0xb6c000, 0x1f400, 0x2cb000, 0x1d500, 0x10000, 0x3, 0x4200, 0x3
    .long 0xb6c400, 0x1f400, 0x2cb100, 0x1d500, 0x10000, 0x3, 0x4200, 0x3
    .long 0xb6c800, 0x1f400, 0x2cb200, 0x1d500, 0x10000, 0x3, 0x4200, 0x3
    .long 0x10b000, 0x1f400, 0x42c00, 0x1ed00, 0x0, 0x1, 0x0, 0x2
    .long 0x10b400, 0x1f400, 0x42d00, 0x1ed00, 0x0, 0x1, 0x0, 0x2
    .long 0x10b800, 0x1f400, 0x42e00, 0x1ed00, 0x0, 0x1, 0x0, 0x2
    .long 0x10bc00, 0x1f400, 0x42f00, 0x1ed00, 0x0, 0x1, 0x0, 0x2
    .long 0xaed000, 0x1f400, 0x2ab400, 0x1f900, 0x10000, 0x3, 0x4200, 0x3
    .long 0xaed400, 0x1f400, 0x2ab500, 0x1f900, 0x10000, 0x3, 0x4200, 0x3
    .long 0xaed800, 0x1f400, 0x2ab600, 0x1f900, 0x10000, 0x3, 0x4200, 0x3
    .long 0xaedc00, 0x1f400, 0x2ab700, 0x1f900, 0x10000, 0x3, 0x4200, 0x3
    .long 0x701800, 0x1f400, 0x1c0600, 0x1f900, 0x0, 0x1, 0x0, 0x2
    .long 0x701c00, 0x1f400, 0x1c0700, 0x1f900, 0x0, 0x1, 0x0, 0x2
    .long 0x701000, 0x1f400, 0x1c0400, 0x1f900, 0x0, 0x1, 0x0, 0x2
    .long 0x701400, 0x1f400, 0x1c0500, 0x1f900, 0x0, 0x1, 0x0, 0x2
    .long 0x101a800, 0x1f400, 0x3f6a00, 0x2f900, 0x10000, 0x3, 0x4200, 0x3
    .long 0x101ac00, 0x1f400, 0x3f6b00, 0x2f900, 0x10000, 0x3, 0x4200, 0x3
    .long 0x101a000, 0x1f400, 0x3f6800, 0x2f900, 0x10000, 0x3, 0x4200, 0x3
    .long 0x101a400, 0x1f400, 0x3f6900, 0x2f900, 0x10000, 0x3, 0x4200, 0x3
    .long 0xc00, 0x1f400, 0x300, 0x42900, 0x0, 0x1, 0x0, 0x3
    .long 0x0, 0x1f400, 0x0, 0x42900, 0x0, 0x1, 0x0, 0x3
    .long 0x400, 0x1f400, 0x100, 0x42900, 0x0, 0x1, 0x0, 0x3
    .long 0x800, 0x1f400, 0x200, 0x42900, 0x0, 0x1, 0x0, 0x3
    .long 0x672400, 0x1f400, 0x18c900, 0x33900, 0x10000, 0x3, 0x4200, 0x3
    .long 0x672800, 0x1f400, 0x18ca00, 0x33900, 0x10000, 0x3, 0x4200, 0x3
    .long 0x672c00, 0x1f400, 0x18cb00, 0x33900, 0x10000, 0x3, 0x4200, 0x3
    .long 0x672000, 0x1f400, 0x18c800, 0x33900, 0x10000, 0x3, 0x4200, 0x3
    .long 0x2de800, 0x1f400, 0xb7a00, 0x66900, 0x0, 0x1, 0x0, 0x3
    .long 0x2dec00, 0x1f400, 0xb7b00, 0x66900, 0x0, 0x1, 0x0, 0x3
    .long 0x2de000, 0x1f400, 0xb7800, 0x66900, 0x0, 0x1, 0x0, 0x3
    .long 0x2de400, 0x1f400, 0xb7900, 0x66900, 0x0, 0x1, 0x0, 0x3
    .long 0xd0c000, 0x1f400, 0x333000, 0x44500, 0x10000, 0x3, 0x4200, 0x3
    .long 0xd0c400, 0x1f400, 0x333100, 0x44500, 0x10000, 0x3, 0x4200, 0x3
    .long 0xd0c800, 0x1f400, 0x333200, 0x44500, 0x10000, 0x3, 0x4200, 0x3
    .long 0xd0cc00, 0x1f400, 0x333300, 0x44500, 0x10000, 0x3, 0x4200, 0x3
    .long 0x8d5400, 0x1f400, 0x235500, 0x75d00, 0x0, 0x1, 0x0, 0x3
    .long 0x8d5800, 0x1f400, 0x235600, 0x75d00, 0x0, 0x1, 0x0, 0x3
    .long 0x8d5c00, 0x1f400, 0x235700, 0x75d00, 0x0, 0x1, 0x0, 0x3
    .long 0x8d5000, 0x1f400, 0x235400, 0x75d00, 0x0, 0x1, 0x0, 0x3
    .long 0xbe2c00, 0x1f400, 0x2e8b00, 0x4a500, 0x10000, 0x3, 0x4200, 0x3
    .long 0xbe2000, 0x1f400, 0x2e8800, 0x4a500, 0x10000, 0x3, 0x4200, 0x3
    .long 0xbe2400, 0x1f400, 0x2e8900, 0x4a500, 0x10000, 0x3, 0x4200, 0x3
    .long 0xbe2800, 0x1f400, 0x2e8a00, 0x4a500, 0x10000, 0x3, 0x4200, 0x3
    .long 0x5ee400, 0x1f400, 0x173900, 0x18d00, 0x8000, 0x2, 0x2100, 0x3
    .long 0x5ee800, 0x1f400, 0x173a00, 0x18d00, 0x8000, 0x2, 0x2100, 0x3
    .long 0x5eec00, 0x1f400, 0x173b00, 0x18d00, 0x8000, 0x2, 0x2100, 0x3
    .long 0x5ee000, 0x1f400, 0x173800, 0x18d00, 0x8000, 0x2, 0x2100, 0x3
    .long 0x7c0800, 0x1f400, 0x1e0200, 0x55100, 0x10000, 0x3, 0x4200, 0x3
    .long 0x7c0c00, 0x1f400, 0x1e0300, 0x55100, 0x10000, 0x3, 0x4200, 0x3
    .long 0x7c0000, 0x1f400, 0x1e0000, 0x55100, 0x10000, 0x3, 0x4200, 0x3
    .long 0x7c0400, 0x1f400, 0x1e0100, 0x55100, 0x10000, 0x3, 0x4200, 0x3
    .long 0x12b000, 0x1f400, 0x42c00, 0x1ed00, 0x8000, 0x2, 0x2100, 0x3
    .long 0x12b400, 0x1f400, 0x42d00, 0x1ed00, 0x8000, 0x2, 0x2100, 0x3
    .long 0x12b800, 0x1f400, 0x42e00, 0x1ed00, 0x8000, 0x2, 0x2100, 0x3
    .long 0x12bc00, 0x1f400, 0x42f00, 0x1ed00, 0x8000, 0x2, 0x2100, 0x3
    .long 0x4b9400, 0x1f400, 0x11e500, 0x55100, 0x10000, 0x3, 0x4200, 0x3
    .long 0x4b9800, 0x1f400, 0x11e600, 0x55100, 0x10000, 0x3, 0x4200, 0x3
    .long 0x4b9c00, 0x1f400, 0x11e700, 0x55100, 0x10000, 0x3, 0x4200, 0x3
    .long 0x4b9000, 0x1f400, 0x11e400, 0x55100, 0x10000, 0x3, 0x4200, 0x3
    .long 0x721800, 0x1f400, 0x1c0600, 0x1f900, 0x8000, 0x2, 0x2100, 0x3
    .long 0x721c00, 0x1f400, 0x1c0700, 0x1f900, 0x8000, 0x2, 0x2100, 0x3
    .long 0x721000, 0x1f400, 0x1c0400, 0x1f900, 0x8000, 0x2, 0x2100, 0x3
    .long 0x721400, 0x1f400, 0x1c0500, 0x1f900, 0x8000, 0x2, 0x2100, 0x3
    .long 0x1c7000, 0x1f400, 0x61c00, 0x55900, 0x10000, 0x3, 0x4200, 0x3
    .long 0x1c7400, 0x1f400, 0x61d00, 0x55900, 0x10000, 0x3, 0x4200, 0x3
    .long 0x1c7800, 0x1f400, 0x61e00, 0x55900, 0x10000, 0x3, 0x4200, 0x3
    .long 0x1c7c00, 0x1f400, 0x61f00, 0x55900, 0x10000, 0x3, 0x4200, 0x3
    .long 0x20c00, 0x1f400, 0x300, 0x42900, 0x8000, 0x2, 0x2100, 0x3
    .long 0x20000, 0x1f400, 0x0, 0x42900, 0x8000, 0x2, 0x2100, 0x3
    .long 0x20400, 0x1f400, 0x100, 0x42900, 0x8000, 0x2, 0x2100, 0x3
    .long 0x20800, 0x1f400, 0x200, 0x42900, 0x8000, 0x2, 0x2100, 0x3
    .long 0xb8cc00, 0x15400, 0x2cb300, 0x1d500, 0x18000, 0x4, 0x6300, 0x3
    .long 0xb8c000, 0x15400, 0x2cb000, 0x1d500, 0x18000, 0x4, 0x6300, 0x3
    .long 0xb8c400, 0x15400, 0x2cb100, 0x1d500, 0x18000, 0x4, 0x6300, 0x3
    .long 0xb8c800, 0x15400, 0x2cb200, 0x1d500, 0x18000, 0x4, 0x6300, 0x3
    .long 0x2fe800, 0x1f400, 0xb7a00, 0x66900, 0x8000, 0x2, 0x2100, 0x3
    .long 0x2fec00, 0x1f400, 0xb7b00, 0x66900, 0x8000, 0x2, 0x2100, 0x3
    .long 0x2fe000, 0x1f400, 0xb7800, 0x66900, 0x8000, 0x2, 0x2100, 0x3
    .long 0x2fe400, 0x1f400, 0xb7900, 0x66900, 0x8000, 0x2, 0x2100, 0x3
    .long 0xb0d000, 0x1e400, 0x2ab400, 0x1f900, 0x18000, 0x4, 0x6300, 0x3
    .long 0xb0d400, 0x1e400, 0x2ab500, 0x1f900, 0x18000, 0x4, 0x6300, 0x3
    .long 0xb0d800, 0x1e400, 0x2ab600, 0x1f900, 0x18000, 0x4, 0x6300, 0x3
    .long 0xb0dc00, 0x1e400, 0x2ab700, 0x1f900, 0x18000, 0x4, 0x6300, 0x3
    .long 0x8f5400, 0x1f400, 0x235500, 0x75d00, 0x8000, 0x2, 0x2100, 0x3
    .long 0x8f5800, 0x1f400, 0x235600, 0x75d00, 0x8000, 0x2, 0x2100, 0x3
    .long 0x8f5c00, 0x1f400, 0x235700, 0x75d00, 0x8000, 0x2, 0x2100, 0x3
    .long 0x8f5000, 0x1f400, 0x235400, 0x75d00, 0x8000, 0x2, 0x2100, 0x3
    .long 0x103a800, 0x1f400, 0x3f6a00, 0x2f900, 0x18000, 0x4, 0x6300, 0x3
    .long 0x103ac00, 0x1f400, 0x3f6b00, 0x2f900, 0x18000, 0x4, 0x6300, 0x3
    .long 0x103a000, 0x1f400, 0x3f6800, 0x2f900, 0x18000, 0x4, 0x6300, 0x3
    .long 0x103a400, 0x1f400, 0x3f6900, 0x2f900, 0x18000, 0x4, 0x6300, 0x3
    .long 0x60e400, 0x1f400, 0x173900, 0x18d00, 0x10000, 0x3, 0x4200, 0x3
    .long 0x60e800, 0x1f400, 0x173a00, 0x18d00, 0x10000, 0x3, 0x4200, 0x3
    .long 0x60ec00, 0x1f400, 0x173b00, 0x18d00, 0x10000, 0x3, 0x4200, 0x3
    .long 0x60e000, 0x1f400, 0x173800, 0x18d00, 0x10000, 0x3, 0x4200, 0x3
    .long 0x692400, 0x1f400, 0x18c900, 0x33900, 0x18000, 0x4, 0x6300, 0x3
    .long 0x692800, 0x1f400, 0x18ca00, 0x33900, 0x18000, 0x4, 0x6300, 0x3
    .long 0x692c00, 0x1f400, 0x18cb00, 0x33900, 0x18000, 0x4, 0x6300, 0x3
    .long 0x692000, 0x1f400, 0x18c800, 0x33900, 0x18000, 0x4, 0x6300, 0x3
    .long 0x14b000, 0x1f400, 0x42c00, 0x1ed00, 0x10000, 0x3, 0x4200, 0x3
    .long 0x14b400, 0x1f400, 0x42d00, 0x1ed00, 0x10000, 0x3, 0x4200, 0x3
    .long 0x14b800, 0x1f400, 0x42e00, 0x1ed00, 0x10000, 0x3, 0x4200, 0x3
    .long 0x14bc00, 0x1f400, 0x42f00, 0x1ed00, 0x10000, 0x3, 0x4200, 0x3
    .long 0xd2c000, 0x1f400, 0x333000, 0x44500, 0x18000, 0x4, 0x6300, 0x3
    .long 0xd2c400, 0x1f400, 0x333100, 0x44500, 0x18000, 0x4, 0x6300, 0x3
    .long 0xd2c800, 0x1f400, 0x333200, 0x44500, 0x18000, 0x4, 0x6300, 0x3
    .long 0xd2cc00, 0x1f400, 0x333300, 0x44500, 0x18000, 0x4, 0x6300, 0x3
    .long 0x741800, 0x1f400, 0x1c0600, 0x1f900, 0x10000, 0x3, 0x4200, 0x3
    .long 0x741c00, 0x1f400, 0x1c0700, 0x1f900, 0x10000, 0x3, 0x4200, 0x3
    .long 0x741000, 0x1f400, 0x1c0400, 0x1f900, 0x10000, 0x3, 0x4200, 0x3
    .long 0x741400, 0x1f400, 0x1c0500, 0x1f900, 0x10000, 0x3, 0x4200, 0x3
    .long 0xc02c00, 0x1f400, 0x2e8b00, 0x4a500, 0x18000, 0x4, 0x6300, 0x3
    .long 0xc02000, 0x1f400, 0x2e8800, 0x4a500, 0x18000, 0x4, 0x6300, 0x3
    .long 0xc02400, 0x1f400, 0x2e8900, 0x4a500, 0x18000, 0x4, 0x6300, 0x3
    .long 0xc02800, 0x1f400, 0x2e8a00, 0x4a500, 0x18000, 0x4, 0x6300, 0x3
    .long 0x40c00, 0x1f400, 0x300, 0x42900, 0x10000, 0x3, 0x4200, 0x3
    .long 0x40000, 0x1f400, 0x0, 0x42900, 0x10000, 0x3, 0x4200, 0x3
    .long 0x40400, 0x1f400, 0x100, 0x42900, 0x10000, 0x3, 0x4200, 0x3
    .long 0x40800, 0x1f400, 0x200, 0x42900, 0x10000, 0x3, 0x4200, 0x3
    .long 0x7e0800, 0x1f400, 0x1e0200, 0x55100, 0x18000, 0x4, 0x6300, 0x3
    .long 0x7e0c00, 0x1f400, 0x1e0300, 0x55100, 0x18000, 0x4, 0x6300, 0x3
    .long 0x7e0000, 0x1f400, 0x1e0000, 0x55100, 0x18000, 0x4, 0x6300, 0x3
    .long 0x7e0400, 0x1f400, 0x1e0100, 0x55100, 0x18000, 0x4, 0x6300, 0x3
    .long 0x31e800, 0x1f400, 0xb7a00, 0x66900, 0x10000, 0x3, 0x4200, 0x3
    .long 0x31ec00, 0x1f400, 0xb7b00, 0x66900, 0x10000, 0x3, 0x4200, 0x3
    .long 0x31e000, 0x1f400, 0xb7800, 0x66900, 0x10000, 0x3, 0x4200, 0x3
    .long 0x31e400, 0x1f400, 0xb7900, 0x66900, 0x10000, 0x3, 0x4200, 0x3
    .long 0x4d9400, 0x1f400, 0x11e500, 0x55100, 0x18000, 0x4, 0x6300, 0x3
    .long 0x4d9800, 0x1f400, 0x11e600, 0x55100, 0x18000, 0x4, 0x6300, 0x3
    .long 0x4d9c00, 0x1f400, 0x11e700, 0x55100, 0x18000, 0x4, 0x6300, 0x3
    .long 0x4d9000, 0x1f400, 0x11e400, 0x55100, 0x18000, 0x4, 0x6300, 0x3
    .long 0x915400, 0x1f400, 0x235500, 0x75d00, 0x10000, 0x3, 0x4200, 0x3
    .long 0x915800, 0x1f400, 0x235600, 0x75d00, 0x10000, 0x3, 0x4200, 0x3
    .long 0x915c00, 0x1f400, 0x235700, 0x75d00, 0x10000, 0x3, 0x4200, 0x3
    .long 0x915000, 0x1f400, 0x235400, 0x75d00, 0x10000, 0x3, 0x4200, 0x3
    .long 0x1e7000, 0x1f400, 0x61c00, 0x55900, 0x18000, 0x4, 0x6300, 0x3
    .long 0x1e7400, 0x1f400, 0x61d00, 0x55900, 0x18000, 0x4, 0x6300, 0x3
    .long 0x1e7800, 0x1f400, 0x61e00, 0x55900, 0x18000, 0x4, 0x6300, 0x3
    .long 0x1e7c00, 0x1f400, 0x61f00, 0x55900, 0x18000, 0x4, 0x6300, 0x3
    .long 0xe1e000, 0x1f400, 0x377800, 0x7ed00, 0x10000, 0x3, 0x4200, 0x3
    .long 0xe1e400, 0x1f400, 0x377900, 0x7ed00, 0x10000, 0x3, 0x4200, 0x3
    .long 0xe1e800, 0x1f400, 0x377a00, 0x7ed00, 0x10000, 0x3, 0x4200, 0x3
    .long 0xe1ec00, 0x1f400, 0x377b00, 0x7ed00, 0x10000, 0x3, 0x4200, 0x3
    .long 0x105a800, 0x1f400, 0x3f6a00, 0x2f900, 0x20000, 0x5, 0x0, 0x3
    .long 0x105ac00, 0x1f400, 0x3f6b00, 0x2f900, 0x20000, 0x5, 0x0, 0x3
    .long 0x105a000, 0x1f400, 0x3f6800, 0x2f900, 0x20000, 0x5, 0x0, 0x3
    .long 0x105a400, 0x1f400, 0x3f6900, 0x2f900, 0x20000, 0x5, 0x0, 0x3
    .long 0x62e400, 0x3400, 0x173900, 0x18d00, 0x18000, 0x4, 0x6300, 0x3
    .long 0x62e800, 0x3400, 0x173a00, 0x18d00, 0x18000, 0x4, 0x6300, 0x3
    .long 0x62ec00, 0x3400, 0x173b00, 0x18d00, 0x18000, 0x4, 0x6300, 0x3
    .long 0x62e000, 0x3400, 0x173800, 0x18d00, 0x18000, 0x4, 0x6300, 0x3
    .long 0x6b2400, 0x1f400, 0x18c900, 0x33900, 0x20000, 0x5, 0x0, 0x3
    .long 0x6b2800, 0x1f400, 0x18ca00, 0x33900, 0x20000, 0x5, 0x0, 0x3
    .long 0x6b2c00, 0x1f400, 0x18cb00, 0x33900, 0x20000, 0x5, 0x0, 0x3
    .long 0x6b2000, 0x1f400, 0x18c800, 0x33900, 0x20000, 0x5, 0x0, 0x3
    .long 0x16b000, 0x1b400, 0x42c00, 0x1ed00, 0x18000, 0x4, 0x6300, 0x3
    .long 0x16b400, 0x1b400, 0x42d00, 0x1ed00, 0x18000, 0x4, 0x6300, 0x3
    .long 0x16b800, 0x1b400, 0x42e00, 0x1ed00, 0x18000, 0x4, 0x6300, 0x3
    .long 0x16bc00, 0x1b400, 0x42f00, 0x1ed00, 0x18000, 0x4, 0x6300, 0x3
    .long 0xd4c000, 0x1f400, 0x333000, 0x44500, 0x20000, 0x5, 0x0, 0x3
    .long 0xd4c400, 0x1f400, 0x333100, 0x44500, 0x20000, 0x5, 0x0, 0x3
    .long 0xd4c800, 0x1f400, 0x333200, 0x44500, 0x20000, 0x5, 0x0, 0x3
    .long 0xd4cc00, 0x1f400, 0x333300, 0x44500, 0x20000, 0x5, 0x0, 0x3
    .long 0x761800, 0x1e400, 0x1c0600, 0x1f900, 0x18000, 0x4, 0x6300, 0x3
    .long 0x761c00, 0x1e400, 0x1c0700, 0x1f900, 0x18000, 0x4, 0x6300, 0x3
    .long 0x761000, 0x1e400, 0x1c0400, 0x1f900, 0x18000, 0x4, 0x6300, 0x3
    .long 0x761400, 0x1e400, 0x1c0500, 0x1f900, 0x18000, 0x4, 0x6300, 0x3
    .long 0xc22c00, 0x1f400, 0x2e8b00, 0x4a500, 0x20000, 0x5, 0x0, 0x3
    .long 0xc22000, 0x1f400, 0x2e8800, 0x4a500, 0x20000, 0x5, 0x0, 0x3
    .long 0xc22400, 0x1f400, 0x2e8900, 0x4a500, 0x20000, 0x5, 0x0, 0x3
    .long 0xc22800, 0x1f400, 0x2e8a00, 0x4a500, 0x20000, 0x5, 0x0, 0x3
    .long 0x60c00, 0x1f400, 0x300, 0x42900, 0x18000, 0x4, 0x6300, 0x3
    .long 0x60000, 0x1f400, 0x0, 0x42900, 0x18000, 0x4, 0x6300, 0x3
    .long 0x60400, 0x1f400, 0x100, 0x42900, 0x18000, 0x4, 0x6300, 0x3
    .long 0x60800, 0x1f400, 0x200, 0x42900, 0x18000, 0x4, 0x6300, 0x3
    .long 0x800800, 0x1f400, 0x1e0200, 0x55100, 0x20000, 0x5, 0x0, 0x3
    .long 0x800c00, 0x1f400, 0x1e0300, 0x55100, 0x20000, 0x5, 0x0, 0x3
    .long 0x800000, 0x1f400, 0x1e0000, 0x55100, 0x20000, 0x5, 0x0, 0x3
    .long 0x800400, 0x1f400, 0x1e0100, 0x55100, 0x20000, 0x5, 0x0, 0x3
    .long 0x33e800, 0x1f400, 0xb7a00, 0x66900, 0x18000, 0x4, 0x6300, 0x3
    .long 0x33ec00, 0x1f400, 0xb7b00, 0x66900, 0x18000, 0x4, 0x6300, 0x3
    .long 0x33e000, 0x1f400, 0xb7800, 0x66900, 0x18000, 0x4, 0x6300, 0x3
    .long 0x33e400, 0x1f400, 0xb7900, 0x66900, 0x18000, 0x4, 0x6300, 0x3
    .long 0x4f9400, 0x1f400, 0x11e500, 0x55100, 0x20000, 0x5, 0x0, 0x3
    .long 0x4f9800, 0x1f400, 0x11e600, 0x55100, 0x20000, 0x5, 0x0, 0x3
    .long 0x4f9c00, 0x1f400, 0x11e700, 0x55100, 0x20000, 0x5, 0x0, 0x3
    .long 0x4f9000, 0x1f400, 0x11e400, 0x55100, 0x20000, 0x5, 0x0, 0x3
    .long 0x935400, 0x1f400, 0x235500, 0x75d00, 0x18000, 0x4, 0x6300, 0x3
    .long 0x935800, 0x1f400, 0x235600, 0x75d00, 0x18000, 0x4, 0x6300, 0x3
    .long 0x935c00, 0x1f400, 0x235700, 0x75d00, 0x18000, 0x4, 0x6300, 0x3
    .long 0x935000, 0x1f400, 0x235400, 0x75d00, 0x18000, 0x4, 0x6300, 0x3
    .long 0x207000, 0x1f400, 0x61c00, 0x55900, 0x20000, 0x5, 0x0, 0x3
    .long 0x207400, 0x1f400, 0x61d00, 0x55900, 0x20000, 0x5, 0x0, 0x3
    .long 0x207800, 0x1f400, 0x61e00, 0x55900, 0x20000, 0x5, 0x0, 0x3
    .long 0x207c00, 0x1f400, 0x61f00, 0x55900, 0x20000, 0x5, 0x0, 0x3
    .long 0xe3e000, 0x1f400, 0x377800, 0x7ed00, 0x18000, 0x4, 0x6300, 0x3
    .long 0xe3e400, 0x1f400, 0x377900, 0x7ed00, 0x18000, 0x4, 0x6300, 0x3
    .long 0xe3e800, 0x1f400, 0x377a00, 0x7ed00, 0x18000, 0x4, 0x6300, 0x3
    .long 0xe3ec00, 0x1f400, 0x377b00, 0x7ed00, 0x18000, 0x4, 0x6300, 0x3
    .long 0xb4cc00, 0x1f400, 0x2cb300, 0x1d500, 0x8000, 0x2, 0x2100, 0x7
    .long 0xb4c000, 0x1f400, 0x2cb000, 0x1d500, 0x8000, 0x2, 0x2100, 0x7
    .long 0xb4c400, 0x1f400, 0x2cb100, 0x1d500, 0x8000, 0x2, 0x2100, 0x7
    .long 0xb4c800, 0x1f400, 0x2cb200, 0x1d500, 0x8000, 0x2, 0x2100, 0x7
    .long 0x80c00, 0x1f400, 0x300, 0x42900, 0x20000, 0x5, 0x0, 0x3
    .long 0x80000, 0x1f400, 0x0, 0x42900, 0x20000, 0x5, 0x0, 0x3
    .long 0x80400, 0x1f400, 0x100, 0x42900, 0x20000, 0x5, 0x0, 0x3
    .long 0x80800, 0x1f400, 0x200, 0x42900, 0x20000, 0x5, 0x0, 0x3
    .long 0xacd000, 0x1f400, 0x2ab400, 0x1f900, 0x8000, 0x2, 0x2100, 0x7
    .long 0xacd400, 0x1f400, 0x2ab500, 0x1f900, 0x8000, 0x2, 0x2100, 0x7
    .long 0xacd800, 0x1f400, 0x2ab600, 0x1f900, 0x8000, 0x2, 0x2100, 0x7
    .long 0xacdc00, 0x1f400, 0x2ab700, 0x1f900, 0x8000, 0x2, 0x2100, 0x7
    .long 0x35e800, 0x1f400, 0xb7a00, 0x66900, 0x20000, 0x5, 0x0, 0x3
    .long 0x35ec00, 0x1f400, 0xb7b00, 0x66900, 0x20000, 0x5, 0x0, 0x3
    .long 0x35e000, 0x1f400, 0xb7800, 0x66900, 0x20000, 0x5, 0x0, 0x3
    .long 0x35e400, 0x1f400, 0xb7900, 0x66900, 0x20000, 0x5, 0x0, 0x3
    .long 0xffa800, 0x1f400, 0x3f6a00, 0x2f900, 0x8000, 0x2, 0x2100, 0x7
    .long 0xffac00, 0x1f400, 0x3f6b00, 0x2f900, 0x8000, 0x2, 0x2100, 0x7
    .long 0xffa000, 0x1f400, 0x3f6800, 0x2f900, 0x8000, 0x2, 0x2100, 0x7
    .long 0xffa400, 0x1f400, 0x3f6900, 0x2f900, 0x8000, 0x2, 0x2100, 0x7
    .long 0x955400, 0x1f400, 0x235500, 0x75d00, 0x20000, 0x5, 0x0, 0x3
    .long 0x955800, 0x1f400, 0x235600, 0x75d00, 0x20000, 0x5, 0x0, 0x3
    .long 0x955c00, 0x1f400, 0x235700, 0x75d00, 0x20000, 0x5, 0x0, 0x3
    .long 0x955000, 0x1f400, 0x235400, 0x75d00, 0x20000, 0x5, 0x0, 0x3
    .long 0x652400, 0x1f400, 0x18c900, 0x33900, 0x8000, 0x2, 0x2100, 0x7
    .long 0x652800, 0x1f400, 0x18ca00, 0x33900, 0x8000, 0x2, 0x2100, 0x7
    .long 0x652c00, 0x1f400, 0x18cb00, 0x33900, 0x8000, 0x2, 0x2100, 0x7
    .long 0x652000, 0x1f400, 0x18c800, 0x33900, 0x8000, 0x2, 0x2100, 0x7
    .long 0xe5e000, 0x1f400, 0x377800, 0x7ed00, 0x20000, 0x5, 0x0, 0x3
    .long 0xe5e400, 0x1f400, 0x377900, 0x7ed00, 0x20000, 0x5, 0x0, 0x3
    .long 0xe5e800, 0x1f400, 0x377a00, 0x7ed00, 0x20000, 0x5, 0x0, 0x3
    .long 0xe5ec00, 0x1f400, 0x377b00, 0x7ed00, 0x20000, 0x5, 0x0, 0x3
    .long 0xcec000, 0x1f400, 0x333000, 0x44500, 0x8000, 0x2, 0x2100, 0x7
    .long 0xcec400, 0x1f400, 0x333100, 0x44500, 0x8000, 0x2, 0x2100, 0x7
    .long 0xcec800, 0x1f400, 0x333200, 0x44500, 0x8000, 0x2, 0x2100, 0x7
    .long 0xcecc00, 0x1f400, 0x333300, 0x44500, 0x8000, 0x2, 0x2100, 0x7
    .long 0xdfe000, 0x1f400, 0x377800, 0x7ed00, 0x8000, 0x2, 0x2100, 0x7
    .long 0xdfe400, 0x1f400, 0x377900, 0x7ed00, 0x8000, 0x2, 0x2100, 0x7
    .long 0xdfe800, 0x1f400, 0x377a00, 0x7ed00, 0x8000, 0x2, 0x2100, 0x7
    .long 0xdfec00, 0x1f400, 0x377b00, 0x7ed00, 0x8000, 0x2, 0x2100, 0x7
    .long 0xbc2c00, 0x1f400, 0x2e8b00, 0x4a500, 0x8000, 0x2, 0x2100, 0x7
    .long 0xbc2000, 0x1f400, 0x2e8800, 0x4a500, 0x8000, 0x2, 0x2100, 0x7
    .long 0xbc2400, 0x1f400, 0x2e8900, 0x4a500, 0x8000, 0x2, 0x2100, 0x7
    .long 0xbc2800, 0x1f400, 0x2e8a00, 0x4a500, 0x8000, 0x2, 0x2100, 0x7
    .long 0xa0c00, 0x1f400, 0x300, 0x42900, 0x28000, 0x6, 0x2100, 0x3
    .long 0xa0000, 0x1f400, 0x0, 0x42900, 0x28000, 0x6, 0x2100, 0x3
    .long 0xa0400, 0x1f400, 0x100, 0x42900, 0x28000, 0x6, 0x2100, 0x3
    .long 0xa0800, 0x1f400, 0x200, 0x42900, 0x28000, 0x6, 0x2100, 0x3
    .long 0x7a0800, 0x1f400, 0x1e0200, 0x55100, 0x8000, 0x2, 0x2100, 0x7
    .long 0x7a0c00, 0x1f400, 0x1e0300, 0x55100, 0x8000, 0x2, 0x2100, 0x7
    .long 0x7a0000, 0x1f400, 0x1e0000, 0x55100, 0x8000, 0x2, 0x2100, 0x7
    .long 0x7a0400, 0x1f400, 0x1e0100, 0x55100, 0x8000, 0x2, 0x2100, 0x7
.size L_table, 16384
.section .rodata,"a"
.p2align 6
.amdhsa_kernel standalone__ragged_sequences_varlen_flash_attn__ragged_kernel
  .amdhsa_next_free_vgpr 256
  .amdhsa_next_free_sgpr 102
  .amdhsa_accum_offset 256
  .amdhsa_group_segment_fixed_size 0
  .amdhsa_kernarg_size 56
  .amdhsa_user_sgpr_count 2
  .amdhsa_user_sgpr_kernarg_segment_ptr 1
  .amdhsa_system_sgpr_workgroup_id_x 1
  .amdhsa_float_denorm_mode_32 3
.end_amdhsa_kernel
```
